```python
import torch

def _softmax(x, axis=-1):
    return torch.softmax(x, dim=axis)
def _gelu(x):
    return torch.nn.functional.gelu(x, approximate="tanh")
def _silu(x):
    return torch.nn.functional.silu(x)
def _sigmoid(x):
    return torch.sigmoid(x)
def _layernorm(x, axis=-1, eps=1e-5):
    m = x.mean(dim=axis, keepdim=True)
    v = x.var(dim=axis, keepdim=True, unbiased=False)
    return (x - m) / torch.sqrt(v + eps)
def _scatter_add(tgt, idx, src, axis=0):
    return tgt.clone().index_add_(axis, idx, src)
def _segment_sum(src, seg, n):
    out = torch.zeros((n,) + src.shape[1:], dtype=src.dtype)
    return out.index_add_(0, seg, src)
def _pad(x, pw):
    flat = tuple(v for pair in reversed(pw) for v in pair)
    return torch.nn.functional.pad(x, flat)

kernel_name = 'concat_heads__gqa_block_cached__gqa_block_cached__near_ridge'

def setup_inputs():

    _w = (lambda a: (lambda t: t.to(torch.bfloat16) if t.is_floating_point() else t)(torch.as_tensor(a)))
    def _A_setup():
        B, Sq, D = 8, 96, 512
        Hq, Hkv, Sk, Dh = 32, 32, 512, 128
        assert Hq % Hkv == 0, (Hq, Hkv)
        return {
            "x": _w((lambda *s: torch.randn(*s, dtype=torch.bfloat16) * 0.8)(B, Sq, D)),
            "k_cache": _w((lambda *s: torch.randn(*s, dtype=torch.bfloat16) * 0.8)(B, Hkv, Sk, Dh)),
            "v_cache": _w((lambda *s: torch.randn(*s, dtype=torch.bfloat16) * 0.05)(B, Hkv, Sk, Dh)),
            "wq": _w((lambda *s: torch.randn(*s, dtype=torch.bfloat16) * 0.8)(D, Hq * Dh) * (D ** -0.5)),
            "wo": _w((lambda *s: torch.randn(*s, dtype=torch.bfloat16) * 0.05)(Hq * Dh, D) * ((Hq * Dh) ** -0.5)),
        }
    _A_in = _A_setup()

    def _B_setup():
        B, Sq, D = 8, 96, 512
        Hq, Hkv, Sk, Dh = 32, 32, 512, 128
        assert Hq % Hkv == 0, (Hq, Hkv)
        return {
            "x": _w((lambda *s: torch.randn(*s, dtype=torch.bfloat16) * 0.8)(B, Sq, D)),
            "k_cache": _w((lambda *s: torch.randn(*s, dtype=torch.bfloat16) * 0.8)(B, Hkv, Sk, Dh)),
            "v_cache": _w((lambda *s: torch.randn(*s, dtype=torch.bfloat16) * 0.05)(B, Hkv, Sk, Dh)),
            "wq": _w((lambda *s: torch.randn(*s, dtype=torch.bfloat16) * 0.8)(D, Hq * Dh) * (D ** -0.5)),
            "wo": _w((lambda *s: torch.randn(*s, dtype=torch.bfloat16) * 0.05)(Hq * Dh, D) * ((Hq * Dh) ** -0.5)),
        }
    _B_in = _B_setup()

    return {
        "A_x": _A_in["x"],
        "A_k_cache": _A_in["k_cache"],
        "A_v_cache": _A_in["v_cache"],
        "A_wq": _A_in["wq"],
        "A_wo": _A_in["wo"],
        "B_x": _B_in["x"],
        "B_k_cache": _B_in["k_cache"],
        "B_v_cache": _B_in["v_cache"],
        "B_wq": _B_in["wq"],
        "B_wo": _B_in["wo"],
    }

def reference(A_x, A_k_cache, A_v_cache, A_wq, A_wo, B_x, B_k_cache, B_v_cache, B_wq, B_wo):
    def _A_ref(x, k_cache, v_cache, wq, wo):
        B, Sq, D = x.shape
        Hq, Dh = 32, 128
        Hkv = k_cache.shape[1]
        rep = Hq // Hkv
        q = (lambda x, *d: x.permute(*d))((x @ wq).reshape(B, Sq, Hq, Dh), 0, 2, 1, 3)
        k = (lambda x, n, axis: torch.repeat_interleave(x, n, dim=axis))(k_cache, rep, axis=1)
        v = (lambda x, n, axis: torch.repeat_interleave(x, n, dim=axis))(v_cache, rep, axis=1)
        scores = torch.einsum("bhqd,bhkd->bhqk", q, k) * (Dh ** -0.5)
        p = _softmax(scores, axis=-1)
        o = torch.einsum("bhqk,bhkd->bhqd", p, v)
        return (lambda x, *d: x.permute(*d))(o, 0, 2, 1, 3).reshape(B, Sq, Hq * Dh) @ wo

    def _B_ref(x, k_cache, v_cache, wq, wo):
        B, Sq, D = x.shape
        Hq, Dh = 32, 128
        Hkv = k_cache.shape[1]
        rep = Hq // Hkv
        q = (lambda x, *d: x.permute(*d))((x @ wq).reshape(B, Sq, Hq, Dh), 0, 2, 1, 3)
        k = (lambda x, n, axis: torch.repeat_interleave(x, n, dim=axis))(k_cache, rep, axis=1)
        v = (lambda x, n, axis: torch.repeat_interleave(x, n, dim=axis))(v_cache, rep, axis=1)
        scores = torch.einsum("bhqd,bhkd->bhqk", q, k) * (Dh ** -0.5)
        p = _softmax(scores, axis=-1)
        o = torch.einsum("bhqk,bhkd->bhqd", p, v)
        return (lambda x, *d: x.permute(*d))(o, 0, 2, 1, 3).reshape(B, Sq, Hq * Dh) @ wo

    a = _A_ref(A_x, A_k_cache, A_v_cache, A_wq, A_wo)
    b = _B_ref(B_x, B_k_cache, B_v_cache, B_wq, B_wo)
    return torch.concatenate([a, b], axis=-1)
```

```asm
; @launch kernel=attn_kernel grid=(512,1,1) block=(256,1,1) lds=65536
; @launch kernel=oproj_kernel grid=(256,1,1) block=(256,1,1) lds=65536
; @launch kernel=reduce_kernel grid=(384,1,1) block=(256,1,1) lds=0
.amdgcn_target "amdgcn-amd-amdhsa--gfx950"
.text
.globl attn_kernel
.p2align 8
.type attn_kernel,@function
attn_kernel:
    s_cmp_ge_u32 s2, 512
    s_cbranch_scc1 A_end
    v_and_b32 v200, 63, v0
    v_lshrrev_b32 v1, 6, v0
    s_nop 0
    v_readfirstlane_b32 s40, v1
    s_lshr_b32 s3, s2, 8
    s_bfe_u32 s4, s2, 0x30005
    s_and_b32 s5, s2, 31
    s_mul_i32 s6, s3, 40
    s_add_u32 s6, s0, s6
    s_addc_u32 s7, s1, 0
    s_load_dwordx4 s[8:11], s[6:7], 0
    s_load_dwordx4 s[12:15], s[6:7], 16
    s_load_dwordx2 s[16:17], s[0:1], 96
    s_waitcnt lgkmcnt(0)
    s_lshl_b32 s41, s4, 5
    s_add_u32 s41, s41, s5
    s_lshl_b32 s41, s41, 17
    s_add_u32 s20, s10, s41
    s_addc_u32 s21, s11, 0
    s_and_b32 s21, s21, 0xffff
    s_mov_b32 s22, 131072
    s_mov_b32 s23, 0x20000
    s_add_u32 s24, s12, s41
    s_addc_u32 s25, s13, 0
    s_and_b32 s25, s25, 0xffff
    s_mov_b32 s26, 131072
    s_mov_b32 s27, 0x20000
    s_lshl_b32 s41, s5, 8
    s_add_u32 s28, s14, s41
    s_addc_u32 s29, s15, 0
    s_and_b32 s29, s29, 0xffff
    s_sub_u32 s30, 4194304, s41
    s_mov_b32 s31, 0x20000
    s_mul_i32 s41, s4, 98304
    s_add_u32 s32, s8, s41
    s_addc_u32 s33, s9, 0
    s_and_b32 s33, s33, 0xffff
    s_mov_b32 s34, 98304
    s_mov_b32 s35, 0x20000
    s_mov_b32 s36, s16
    s_and_b32 s37, s17, 0xffff
    s_mov_b32 s38, 12582912
    s_mov_b32 s39, 0x20000
    s_cmp_eq_u32 s40, 3
    s_cbranch_scc1 A_prod
    v_and_b32 v1, 31, v200
    v_lshrrev_b32 v2, 5, v200
    v_bfe_u32 v3, v200, 2, 2
    v_and_b32 v4, 3, v200
    v_bfe_u32 v5, v200, 4, 1
    v_and_b32 v6, 15, v1
    v_lshlrev_b32 v7, 8, v1
    v_add_u32 v8, 0, v2
    v_xor_b32 v8, v8, v6
    v_lshlrev_b32 v8, 4, v8
    v_add_u32 v176, v7, v8
    v_add_u32 v8, 2, v2
    v_xor_b32 v8, v8, v6
    v_lshlrev_b32 v8, 4, v8
    v_add_u32 v177, v7, v8
    v_add_u32 v8, 4, v2
    v_xor_b32 v8, v8, v6
    v_lshlrev_b32 v8, 4, v8
    v_add_u32 v178, v7, v8
    v_add_u32 v8, 6, v2
    v_xor_b32 v8, v8, v6
    v_lshlrev_b32 v8, 4, v8
    v_add_u32 v179, v7, v8
    v_add_u32 v8, 8, v2
    v_xor_b32 v8, v8, v6
    v_lshlrev_b32 v8, 4, v8
    v_add_u32 v180, v7, v8
    v_add_u32 v8, 10, v2
    v_xor_b32 v8, v8, v6
    v_lshlrev_b32 v8, 4, v8
    v_add_u32 v181, v7, v8
    v_add_u32 v8, 12, v2
    v_xor_b32 v8, v8, v6
    v_lshlrev_b32 v8, 4, v8
    v_add_u32 v182, v7, v8
    v_add_u32 v8, 14, v2
    v_xor_b32 v8, v8, v6
    v_lshlrev_b32 v8, 4, v8
    v_add_u32 v183, v7, v8
    v_and_b32 v8, 1, v4
    v_lshl_add_u32 v8, v5, 1, v8
    v_lshlrev_b32 v8, 4, v8
    v_lshrrev_b32 v9, 1, v4
    v_lshl_add_u32 v8, v9, 3, v8
    v_xor_b32 v9, 0, v3
    v_lshl_add_u32 v9, v9, 6, v8
    v_lshl_add_u32 v10, v2, 2, v3
    v_lshl_add_u32 v184, v10, 8, v9
    v_lshl_add_u32 v10, v2, 3, v3
    v_lshl_add_u32 v188, v10, 8, v9
    v_xor_b32 v9, 1, v3
    v_lshl_add_u32 v9, v9, 6, v8
    v_lshl_add_u32 v10, v2, 2, v3
    v_lshl_add_u32 v185, v10, 8, v9
    v_lshl_add_u32 v10, v2, 3, v3
    v_lshl_add_u32 v189, v10, 8, v9
    v_xor_b32 v9, 2, v3
    v_lshl_add_u32 v9, v9, 6, v8
    v_lshl_add_u32 v10, v2, 2, v3
    v_lshl_add_u32 v186, v10, 8, v9
    v_lshl_add_u32 v10, v2, 3, v3
    v_lshl_add_u32 v190, v10, 8, v9
    v_xor_b32 v9, 3, v3
    v_lshl_add_u32 v9, v9, 6, v8
    v_lshl_add_u32 v10, v2, 2, v3
    v_lshl_add_u32 v187, v10, 8, v9
    v_lshl_add_u32 v10, v2, 3, v3
    v_lshl_add_u32 v191, v10, 8, v9
    s_lshl_b32 s41, s40, 5
    v_add_u32 v8, s41, v1
    v_lshlrev_b32 v8, 10, v8
    v_lshl_add_u32 v192, v2, 4, v8
    s_mul_i32 s42, s3, 768
    s_mul_i32 s43, s4, 96
    s_add_u32 s42, s42, s43
    s_add_u32 s42, s42, s41
    v_add_u32 v8, s42, v1
    v_lshlrev_b32 v8, 13, v8
    s_lshl_b32 s43, s5, 8
    v_add_u32 v8, s43, v8
    v_lshl_add_u32 v199, v2, 4, v8
    s_mov_b32 s44, 0x3e0293ee
    buffer_load_dwordx4 v[152:155], v192, s[32:35], 0 offen offset:0
    buffer_load_dwordx4 v[156:159], v192, s[32:35], 0 offen offset:32
    buffer_load_dwordx4 v[160:163], v192, s[32:35], 0 offen offset:64
    buffer_load_dwordx4 v[164:167], v192, s[32:35], 0 offen offset:96
    buffer_load_dwordx4 v[168:171], v192, s[32:35], 0 offen offset:128
    buffer_load_dwordx4 v[172:175], v192, s[32:35], 0 offen offset:160
    s_barrier
    ds_read_b64_tr_b16 v[120:121], v188 offset:0
    ds_read_b64_tr_b16 v[122:123], v188 offset:1024
    ds_read_b64_tr_b16 v[124:125], v189 offset:0
    ds_read_b64_tr_b16 v[126:127], v189 offset:1024
    ds_read_b64_tr_b16 v[128:129], v190 offset:0
    ds_read_b64_tr_b16 v[130:131], v190 offset:1024
    ds_read_b64_tr_b16 v[132:133], v191 offset:0
    ds_read_b64_tr_b16 v[134:135], v191 offset:1024
    ds_read_b64_tr_b16 v[136:137], v188 offset:4096
    ds_read_b64_tr_b16 v[138:139], v188 offset:5120
    ds_read_b64_tr_b16 v[140:141], v189 offset:4096
    ds_read_b64_tr_b16 v[142:143], v189 offset:5120
    ds_read_b64_tr_b16 v[144:145], v190 offset:4096
    ds_read_b64_tr_b16 v[146:147], v190 offset:5120
    ds_read_b64_tr_b16 v[148:149], v191 offset:4096
    ds_read_b64_tr_b16 v[150:151], v191 offset:5120
    s_waitcnt vmcnt(4) lgkmcnt(0)
    v_mfma_f32_32x32x16_bf16 v[32:47], v[120:123], v[152:155], 0
    v_mfma_f32_32x32x16_bf16 v[48:63], v[124:127], v[152:155], 0
    v_mfma_f32_32x32x16_bf16 v[64:79], v[128:131], v[152:155], 0
    v_mfma_f32_32x32x16_bf16 v[80:95], v[132:135], v[152:155], 0
    v_mfma_f32_32x32x16_bf16 v[32:47], v[136:139], v[156:159], v[32:47]
    v_mfma_f32_32x32x16_bf16 v[48:63], v[140:143], v[156:159], v[48:63]
    v_mfma_f32_32x32x16_bf16 v[64:79], v[144:147], v[156:159], v[64:79]
    v_mfma_f32_32x32x16_bf16 v[80:95], v[148:151], v[156:159], v[80:95]
    buffer_load_dwordx4 v[152:155], v192, s[32:35], 0 offen offset:192
    buffer_load_dwordx4 v[156:159], v192, s[32:35], 0 offen offset:224
    s_barrier
    ds_read_b64_tr_b16 v[120:121], v188 offset:8192
    ds_read_b64_tr_b16 v[122:123], v188 offset:9216
    ds_read_b64_tr_b16 v[124:125], v189 offset:8192
    ds_read_b64_tr_b16 v[126:127], v189 offset:9216
    ds_read_b64_tr_b16 v[128:129], v190 offset:8192
    ds_read_b64_tr_b16 v[130:131], v190 offset:9216
    ds_read_b64_tr_b16 v[132:133], v191 offset:8192
    ds_read_b64_tr_b16 v[134:135], v191 offset:9216
    ds_read_b64_tr_b16 v[136:137], v188 offset:12288
    ds_read_b64_tr_b16 v[138:139], v188 offset:13312
    ds_read_b64_tr_b16 v[140:141], v189 offset:12288
    ds_read_b64_tr_b16 v[142:143], v189 offset:13312
    ds_read_b64_tr_b16 v[144:145], v190 offset:12288
    ds_read_b64_tr_b16 v[146:147], v190 offset:13312
    ds_read_b64_tr_b16 v[148:149], v191 offset:12288
    ds_read_b64_tr_b16 v[150:151], v191 offset:13312
    s_waitcnt vmcnt(4) lgkmcnt(0)
    v_mfma_f32_32x32x16_bf16 v[32:47], v[120:123], v[160:163], v[32:47]
    v_mfma_f32_32x32x16_bf16 v[48:63], v[124:127], v[160:163], v[48:63]
    v_mfma_f32_32x32x16_bf16 v[64:79], v[128:131], v[160:163], v[64:79]
    v_mfma_f32_32x32x16_bf16 v[80:95], v[132:135], v[160:163], v[80:95]
    v_mfma_f32_32x32x16_bf16 v[32:47], v[136:139], v[164:167], v[32:47]
    v_mfma_f32_32x32x16_bf16 v[48:63], v[140:143], v[164:167], v[48:63]
    v_mfma_f32_32x32x16_bf16 v[64:79], v[144:147], v[164:167], v[64:79]
    v_mfma_f32_32x32x16_bf16 v[80:95], v[148:151], v[164:167], v[80:95]
    buffer_load_dwordx4 v[160:163], v192, s[32:35], 0 offen offset:256
    buffer_load_dwordx4 v[164:167], v192, s[32:35], 0 offen offset:288
    s_barrier
    ds_read_b64_tr_b16 v[120:121], v188 offset:16384
    ds_read_b64_tr_b16 v[122:123], v188 offset:17408
    ds_read_b64_tr_b16 v[124:125], v189 offset:16384
    ds_read_b64_tr_b16 v[126:127], v189 offset:17408
    ds_read_b64_tr_b16 v[128:129], v190 offset:16384
    ds_read_b64_tr_b16 v[130:131], v190 offset:17408
    ds_read_b64_tr_b16 v[132:133], v191 offset:16384
    ds_read_b64_tr_b16 v[134:135], v191 offset:17408
    ds_read_b64_tr_b16 v[136:137], v188 offset:20480
    ds_read_b64_tr_b16 v[138:139], v188 offset:21504
    ds_read_b64_tr_b16 v[140:141], v189 offset:20480
    ds_read_b64_tr_b16 v[142:143], v189 offset:21504
    ds_read_b64_tr_b16 v[144:145], v190 offset:20480
    ds_read_b64_tr_b16 v[146:147], v190 offset:21504
    ds_read_b64_tr_b16 v[148:149], v191 offset:20480
    ds_read_b64_tr_b16 v[150:151], v191 offset:21504
    s_waitcnt vmcnt(4) lgkmcnt(0)
    v_mfma_f32_32x32x16_bf16 v[32:47], v[120:123], v[168:171], v[32:47]
    v_mfma_f32_32x32x16_bf16 v[48:63], v[124:127], v[168:171], v[48:63]
    v_mfma_f32_32x32x16_bf16 v[64:79], v[128:131], v[168:171], v[64:79]
    v_mfma_f32_32x32x16_bf16 v[80:95], v[132:135], v[168:171], v[80:95]
    v_mfma_f32_32x32x16_bf16 v[32:47], v[136:139], v[172:175], v[32:47]
    v_mfma_f32_32x32x16_bf16 v[48:63], v[140:143], v[172:175], v[48:63]
    v_mfma_f32_32x32x16_bf16 v[64:79], v[144:147], v[172:175], v[64:79]
    v_mfma_f32_32x32x16_bf16 v[80:95], v[148:151], v[172:175], v[80:95]
    buffer_load_dwordx4 v[168:171], v192, s[32:35], 0 offen offset:320
    buffer_load_dwordx4 v[172:175], v192, s[32:35], 0 offen offset:352
    s_barrier
    ds_read_b64_tr_b16 v[120:121], v188 offset:24576
    ds_read_b64_tr_b16 v[122:123], v188 offset:25600
    ds_read_b64_tr_b16 v[124:125], v189 offset:24576
    ds_read_b64_tr_b16 v[126:127], v189 offset:25600
    ds_read_b64_tr_b16 v[128:129], v190 offset:24576
    ds_read_b64_tr_b16 v[130:131], v190 offset:25600
    ds_read_b64_tr_b16 v[132:133], v191 offset:24576
    ds_read_b64_tr_b16 v[134:135], v191 offset:25600
    ds_read_b64_tr_b16 v[136:137], v188 offset:28672
    ds_read_b64_tr_b16 v[138:139], v188 offset:29696
    ds_read_b64_tr_b16 v[140:141], v189 offset:28672
    ds_read_b64_tr_b16 v[142:143], v189 offset:29696
    ds_read_b64_tr_b16 v[144:145], v190 offset:28672
    ds_read_b64_tr_b16 v[146:147], v190 offset:29696
    ds_read_b64_tr_b16 v[148:149], v191 offset:28672
    ds_read_b64_tr_b16 v[150:151], v191 offset:29696
    s_waitcnt vmcnt(4) lgkmcnt(0)
    v_mfma_f32_32x32x16_bf16 v[32:47], v[120:123], v[152:155], v[32:47]
    v_mfma_f32_32x32x16_bf16 v[48:63], v[124:127], v[152:155], v[48:63]
    v_mfma_f32_32x32x16_bf16 v[64:79], v[128:131], v[152:155], v[64:79]
    v_mfma_f32_32x32x16_bf16 v[80:95], v[132:135], v[152:155], v[80:95]
    v_mfma_f32_32x32x16_bf16 v[32:47], v[136:139], v[156:159], v[32:47]
    v_mfma_f32_32x32x16_bf16 v[48:63], v[140:143], v[156:159], v[48:63]
    v_mfma_f32_32x32x16_bf16 v[64:79], v[144:147], v[156:159], v[64:79]
    v_mfma_f32_32x32x16_bf16 v[80:95], v[148:151], v[156:159], v[80:95]
    buffer_load_dwordx4 v[152:155], v192, s[32:35], 0 offen offset:384
    buffer_load_dwordx4 v[156:159], v192, s[32:35], 0 offen offset:416
    s_barrier
    ds_read_b64_tr_b16 v[120:121], v188 offset:32768
    ds_read_b64_tr_b16 v[122:123], v188 offset:33792
    ds_read_b64_tr_b16 v[124:125], v189 offset:32768
    ds_read_b64_tr_b16 v[126:127], v189 offset:33792
    ds_read_b64_tr_b16 v[128:129], v190 offset:32768
    ds_read_b64_tr_b16 v[130:131], v190 offset:33792
    ds_read_b64_tr_b16 v[132:133], v191 offset:32768
    ds_read_b64_tr_b16 v[134:135], v191 offset:33792
    ds_read_b64_tr_b16 v[136:137], v188 offset:36864
    ds_read_b64_tr_b16 v[138:139], v188 offset:37888
    ds_read_b64_tr_b16 v[140:141], v189 offset:36864
    ds_read_b64_tr_b16 v[142:143], v189 offset:37888
    ds_read_b64_tr_b16 v[144:145], v190 offset:36864
    ds_read_b64_tr_b16 v[146:147], v190 offset:37888
    ds_read_b64_tr_b16 v[148:149], v191 offset:36864
    ds_read_b64_tr_b16 v[150:151], v191 offset:37888
    s_waitcnt vmcnt(4) lgkmcnt(0)
    v_mfma_f32_32x32x16_bf16 v[32:47], v[120:123], v[160:163], v[32:47]
    v_mfma_f32_32x32x16_bf16 v[48:63], v[124:127], v[160:163], v[48:63]
    v_mfma_f32_32x32x16_bf16 v[64:79], v[128:131], v[160:163], v[64:79]
    v_mfma_f32_32x32x16_bf16 v[80:95], v[132:135], v[160:163], v[80:95]
    v_mfma_f32_32x32x16_bf16 v[32:47], v[136:139], v[164:167], v[32:47]
    v_mfma_f32_32x32x16_bf16 v[48:63], v[140:143], v[164:167], v[48:63]
    v_mfma_f32_32x32x16_bf16 v[64:79], v[144:147], v[164:167], v[64:79]
    v_mfma_f32_32x32x16_bf16 v[80:95], v[148:151], v[164:167], v[80:95]
    buffer_load_dwordx4 v[160:163], v192, s[32:35], 0 offen offset:448
    buffer_load_dwordx4 v[164:167], v192, s[32:35], 0 offen offset:480
    s_barrier
    ds_read_b64_tr_b16 v[120:121], v188 offset:40960
    ds_read_b64_tr_b16 v[122:123], v188 offset:41984
    ds_read_b64_tr_b16 v[124:125], v189 offset:40960
    ds_read_b64_tr_b16 v[126:127], v189 offset:41984
    ds_read_b64_tr_b16 v[128:129], v190 offset:40960
    ds_read_b64_tr_b16 v[130:131], v190 offset:41984
    ds_read_b64_tr_b16 v[132:133], v191 offset:40960
    ds_read_b64_tr_b16 v[134:135], v191 offset:41984
    ds_read_b64_tr_b16 v[136:137], v188 offset:45056
    ds_read_b64_tr_b16 v[138:139], v188 offset:46080
    ds_read_b64_tr_b16 v[140:141], v189 offset:45056
    ds_read_b64_tr_b16 v[142:143], v189 offset:46080
    ds_read_b64_tr_b16 v[144:145], v190 offset:45056
    ds_read_b64_tr_b16 v[146:147], v190 offset:46080
    ds_read_b64_tr_b16 v[148:149], v191 offset:45056
    ds_read_b64_tr_b16 v[150:151], v191 offset:46080
    s_waitcnt vmcnt(4) lgkmcnt(0)
    v_mfma_f32_32x32x16_bf16 v[32:47], v[120:123], v[168:171], v[32:47]
    v_mfma_f32_32x32x16_bf16 v[48:63], v[124:127], v[168:171], v[48:63]
    v_mfma_f32_32x32x16_bf16 v[64:79], v[128:131], v[168:171], v[64:79]
    v_mfma_f32_32x32x16_bf16 v[80:95], v[132:135], v[168:171], v[80:95]
    v_mfma_f32_32x32x16_bf16 v[32:47], v[136:139], v[172:175], v[32:47]
    v_mfma_f32_32x32x16_bf16 v[48:63], v[140:143], v[172:175], v[48:63]
    v_mfma_f32_32x32x16_bf16 v[64:79], v[144:147], v[172:175], v[64:79]
    v_mfma_f32_32x32x16_bf16 v[80:95], v[148:151], v[172:175], v[80:95]
    buffer_load_dwordx4 v[168:171], v192, s[32:35], 0 offen offset:512
    buffer_load_dwordx4 v[172:175], v192, s[32:35], 0 offen offset:544
    s_barrier
    ds_read_b64_tr_b16 v[120:121], v188 offset:49152
    ds_read_b64_tr_b16 v[122:123], v188 offset:50176
    ds_read_b64_tr_b16 v[124:125], v189 offset:49152
    ds_read_b64_tr_b16 v[126:127], v189 offset:50176
    ds_read_b64_tr_b16 v[128:129], v190 offset:49152
    ds_read_b64_tr_b16 v[130:131], v190 offset:50176
    ds_read_b64_tr_b16 v[132:133], v191 offset:49152
    ds_read_b64_tr_b16 v[134:135], v191 offset:50176
    ds_read_b64_tr_b16 v[136:137], v188 offset:53248
    ds_read_b64_tr_b16 v[138:139], v188 offset:54272
    ds_read_b64_tr_b16 v[140:141], v189 offset:53248
    ds_read_b64_tr_b16 v[142:143], v189 offset:54272
    ds_read_b64_tr_b16 v[144:145], v190 offset:53248
    ds_read_b64_tr_b16 v[146:147], v190 offset:54272
    ds_read_b64_tr_b16 v[148:149], v191 offset:53248
    ds_read_b64_tr_b16 v[150:151], v191 offset:54272
    s_waitcnt vmcnt(4) lgkmcnt(0)
    v_mfma_f32_32x32x16_bf16 v[32:47], v[120:123], v[152:155], v[32:47]
    v_mfma_f32_32x32x16_bf16 v[48:63], v[124:127], v[152:155], v[48:63]
    v_mfma_f32_32x32x16_bf16 v[64:79], v[128:131], v[152:155], v[64:79]
    v_mfma_f32_32x32x16_bf16 v[80:95], v[132:135], v[152:155], v[80:95]
    v_mfma_f32_32x32x16_bf16 v[32:47], v[136:139], v[156:159], v[32:47]
    v_mfma_f32_32x32x16_bf16 v[48:63], v[140:143], v[156:159], v[48:63]
    v_mfma_f32_32x32x16_bf16 v[64:79], v[144:147], v[156:159], v[64:79]
    v_mfma_f32_32x32x16_bf16 v[80:95], v[148:151], v[156:159], v[80:95]
    buffer_load_dwordx4 v[152:155], v192, s[32:35], 0 offen offset:576
    buffer_load_dwordx4 v[156:159], v192, s[32:35], 0 offen offset:608
    s_barrier
    ds_read_b64_tr_b16 v[120:121], v188 offset:57344
    ds_read_b64_tr_b16 v[122:123], v188 offset:58368
    ds_read_b64_tr_b16 v[124:125], v189 offset:57344
    ds_read_b64_tr_b16 v[126:127], v189 offset:58368
    ds_read_b64_tr_b16 v[128:129], v190 offset:57344
    ds_read_b64_tr_b16 v[130:131], v190 offset:58368
    ds_read_b64_tr_b16 v[132:133], v191 offset:57344
    ds_read_b64_tr_b16 v[134:135], v191 offset:58368
    ds_read_b64_tr_b16 v[136:137], v188 offset:61440
    ds_read_b64_tr_b16 v[138:139], v188 offset:62464
    ds_read_b64_tr_b16 v[140:141], v189 offset:61440
    ds_read_b64_tr_b16 v[142:143], v189 offset:62464
    ds_read_b64_tr_b16 v[144:145], v190 offset:61440
    ds_read_b64_tr_b16 v[146:147], v190 offset:62464
    ds_read_b64_tr_b16 v[148:149], v191 offset:61440
    ds_read_b64_tr_b16 v[150:151], v191 offset:62464
    s_waitcnt vmcnt(4) lgkmcnt(0)
    v_mfma_f32_32x32x16_bf16 v[32:47], v[120:123], v[160:163], v[32:47]
    v_mfma_f32_32x32x16_bf16 v[48:63], v[124:127], v[160:163], v[48:63]
    v_mfma_f32_32x32x16_bf16 v[64:79], v[128:131], v[160:163], v[64:79]
    v_mfma_f32_32x32x16_bf16 v[80:95], v[132:135], v[160:163], v[80:95]
    v_mfma_f32_32x32x16_bf16 v[32:47], v[136:139], v[164:167], v[32:47]
    v_mfma_f32_32x32x16_bf16 v[48:63], v[140:143], v[164:167], v[48:63]
    v_mfma_f32_32x32x16_bf16 v[64:79], v[144:147], v[164:167], v[64:79]
    v_mfma_f32_32x32x16_bf16 v[80:95], v[148:151], v[164:167], v[80:95]
    buffer_load_dwordx4 v[160:163], v192, s[32:35], 0 offen offset:640
    buffer_load_dwordx4 v[164:167], v192, s[32:35], 0 offen offset:672
    s_barrier
    ds_read_b64_tr_b16 v[120:121], v188 offset:0
    ds_read_b64_tr_b16 v[122:123], v188 offset:1024
    ds_read_b64_tr_b16 v[124:125], v189 offset:0
    ds_read_b64_tr_b16 v[126:127], v189 offset:1024
    ds_read_b64_tr_b16 v[128:129], v190 offset:0
    ds_read_b64_tr_b16 v[130:131], v190 offset:1024
    ds_read_b64_tr_b16 v[132:133], v191 offset:0
    ds_read_b64_tr_b16 v[134:135], v191 offset:1024
    ds_read_b64_tr_b16 v[136:137], v188 offset:4096
    ds_read_b64_tr_b16 v[138:139], v188 offset:5120
    ds_read_b64_tr_b16 v[140:141], v189 offset:4096
    ds_read_b64_tr_b16 v[142:143], v189 offset:5120
    ds_read_b64_tr_b16 v[144:145], v190 offset:4096
    ds_read_b64_tr_b16 v[146:147], v190 offset:5120
    ds_read_b64_tr_b16 v[148:149], v191 offset:4096
    ds_read_b64_tr_b16 v[150:151], v191 offset:5120
    s_waitcnt vmcnt(4) lgkmcnt(0)
    v_mfma_f32_32x32x16_bf16 v[32:47], v[120:123], v[168:171], v[32:47]
    v_mfma_f32_32x32x16_bf16 v[48:63], v[124:127], v[168:171], v[48:63]
    v_mfma_f32_32x32x16_bf16 v[64:79], v[128:131], v[168:171], v[64:79]
    v_mfma_f32_32x32x16_bf16 v[80:95], v[132:135], v[168:171], v[80:95]
    v_mfma_f32_32x32x16_bf16 v[32:47], v[136:139], v[172:175], v[32:47]
    v_mfma_f32_32x32x16_bf16 v[48:63], v[140:143], v[172:175], v[48:63]
    v_mfma_f32_32x32x16_bf16 v[64:79], v[144:147], v[172:175], v[64:79]
    v_mfma_f32_32x32x16_bf16 v[80:95], v[148:151], v[172:175], v[80:95]
    buffer_load_dwordx4 v[168:171], v192, s[32:35], 0 offen offset:704
    buffer_load_dwordx4 v[172:175], v192, s[32:35], 0 offen offset:736
    s_barrier
    ds_read_b64_tr_b16 v[120:121], v188 offset:8192
    ds_read_b64_tr_b16 v[122:123], v188 offset:9216
    ds_read_b64_tr_b16 v[124:125], v189 offset:8192
    ds_read_b64_tr_b16 v[126:127], v189 offset:9216
    ds_read_b64_tr_b16 v[128:129], v190 offset:8192
    ds_read_b64_tr_b16 v[130:131], v190 offset:9216
    ds_read_b64_tr_b16 v[132:133], v191 offset:8192
    ds_read_b64_tr_b16 v[134:135], v191 offset:9216
    ds_read_b64_tr_b16 v[136:137], v188 offset:12288
    ds_read_b64_tr_b16 v[138:139], v188 offset:13312
    ds_read_b64_tr_b16 v[140:141], v189 offset:12288
    ds_read_b64_tr_b16 v[142:143], v189 offset:13312
    ds_read_b64_tr_b16 v[144:145], v190 offset:12288
    ds_read_b64_tr_b16 v[146:147], v190 offset:13312
    ds_read_b64_tr_b16 v[148:149], v191 offset:12288
    ds_read_b64_tr_b16 v[150:151], v191 offset:13312
    s_waitcnt vmcnt(4) lgkmcnt(0)
    v_mfma_f32_32x32x16_bf16 v[32:47], v[120:123], v[152:155], v[32:47]
    v_mfma_f32_32x32x16_bf16 v[48:63], v[124:127], v[152:155], v[48:63]
    v_mfma_f32_32x32x16_bf16 v[64:79], v[128:131], v[152:155], v[64:79]
    v_mfma_f32_32x32x16_bf16 v[80:95], v[132:135], v[152:155], v[80:95]
    v_mfma_f32_32x32x16_bf16 v[32:47], v[136:139], v[156:159], v[32:47]
    v_mfma_f32_32x32x16_bf16 v[48:63], v[140:143], v[156:159], v[48:63]
    v_mfma_f32_32x32x16_bf16 v[64:79], v[144:147], v[156:159], v[64:79]
    v_mfma_f32_32x32x16_bf16 v[80:95], v[148:151], v[156:159], v[80:95]
    buffer_load_dwordx4 v[152:155], v192, s[32:35], 0 offen offset:768
    buffer_load_dwordx4 v[156:159], v192, s[32:35], 0 offen offset:800
    s_barrier
    ds_read_b64_tr_b16 v[120:121], v188 offset:16384
    ds_read_b64_tr_b16 v[122:123], v188 offset:17408
    ds_read_b64_tr_b16 v[124:125], v189 offset:16384
    ds_read_b64_tr_b16 v[126:127], v189 offset:17408
    ds_read_b64_tr_b16 v[128:129], v190 offset:16384
    ds_read_b64_tr_b16 v[130:131], v190 offset:17408
    ds_read_b64_tr_b16 v[132:133], v191 offset:16384
    ds_read_b64_tr_b16 v[134:135], v191 offset:17408
    ds_read_b64_tr_b16 v[136:137], v188 offset:20480
    ds_read_b64_tr_b16 v[138:139], v188 offset:21504
    ds_read_b64_tr_b16 v[140:141], v189 offset:20480
    ds_read_b64_tr_b16 v[142:143], v189 offset:21504
    ds_read_b64_tr_b16 v[144:145], v190 offset:20480
    ds_read_b64_tr_b16 v[146:147], v190 offset:21504
    ds_read_b64_tr_b16 v[148:149], v191 offset:20480
    ds_read_b64_tr_b16 v[150:151], v191 offset:21504
    s_waitcnt vmcnt(4) lgkmcnt(0)
    v_mfma_f32_32x32x16_bf16 v[32:47], v[120:123], v[160:163], v[32:47]
    v_mfma_f32_32x32x16_bf16 v[48:63], v[124:127], v[160:163], v[48:63]
    v_mfma_f32_32x32x16_bf16 v[64:79], v[128:131], v[160:163], v[64:79]
    v_mfma_f32_32x32x16_bf16 v[80:95], v[132:135], v[160:163], v[80:95]
    v_mfma_f32_32x32x16_bf16 v[32:47], v[136:139], v[164:167], v[32:47]
    v_mfma_f32_32x32x16_bf16 v[48:63], v[140:143], v[164:167], v[48:63]
    v_mfma_f32_32x32x16_bf16 v[64:79], v[144:147], v[164:167], v[64:79]
    v_mfma_f32_32x32x16_bf16 v[80:95], v[148:151], v[164:167], v[80:95]
    buffer_load_dwordx4 v[160:163], v192, s[32:35], 0 offen offset:832
    buffer_load_dwordx4 v[164:167], v192, s[32:35], 0 offen offset:864
    s_barrier
    ds_read_b64_tr_b16 v[120:121], v188 offset:24576
    ds_read_b64_tr_b16 v[122:123], v188 offset:25600
    ds_read_b64_tr_b16 v[124:125], v189 offset:24576
    ds_read_b64_tr_b16 v[126:127], v189 offset:25600
    ds_read_b64_tr_b16 v[128:129], v190 offset:24576
    ds_read_b64_tr_b16 v[130:131], v190 offset:25600
    ds_read_b64_tr_b16 v[132:133], v191 offset:24576
    ds_read_b64_tr_b16 v[134:135], v191 offset:25600
    ds_read_b64_tr_b16 v[136:137], v188 offset:28672
    ds_read_b64_tr_b16 v[138:139], v188 offset:29696
    ds_read_b64_tr_b16 v[140:141], v189 offset:28672
    ds_read_b64_tr_b16 v[142:143], v189 offset:29696
    ds_read_b64_tr_b16 v[144:145], v190 offset:28672
    ds_read_b64_tr_b16 v[146:147], v190 offset:29696
    ds_read_b64_tr_b16 v[148:149], v191 offset:28672
    ds_read_b64_tr_b16 v[150:151], v191 offset:29696
    s_waitcnt vmcnt(4) lgkmcnt(0)
    v_mfma_f32_32x32x16_bf16 v[32:47], v[120:123], v[168:171], v[32:47]
    v_mfma_f32_32x32x16_bf16 v[48:63], v[124:127], v[168:171], v[48:63]
    v_mfma_f32_32x32x16_bf16 v[64:79], v[128:131], v[168:171], v[64:79]
    v_mfma_f32_32x32x16_bf16 v[80:95], v[132:135], v[168:171], v[80:95]
    v_mfma_f32_32x32x16_bf16 v[32:47], v[136:139], v[172:175], v[32:47]
    v_mfma_f32_32x32x16_bf16 v[48:63], v[140:143], v[172:175], v[48:63]
    v_mfma_f32_32x32x16_bf16 v[64:79], v[144:147], v[172:175], v[64:79]
    v_mfma_f32_32x32x16_bf16 v[80:95], v[148:151], v[172:175], v[80:95]
    buffer_load_dwordx4 v[168:171], v192, s[32:35], 0 offen offset:896
    buffer_load_dwordx4 v[172:175], v192, s[32:35], 0 offen offset:928
    s_barrier
    ds_read_b64_tr_b16 v[120:121], v188 offset:32768
    ds_read_b64_tr_b16 v[122:123], v188 offset:33792
    ds_read_b64_tr_b16 v[124:125], v189 offset:32768
    ds_read_b64_tr_b16 v[126:127], v189 offset:33792
    ds_read_b64_tr_b16 v[128:129], v190 offset:32768
    ds_read_b64_tr_b16 v[130:131], v190 offset:33792
    ds_read_b64_tr_b16 v[132:133], v191 offset:32768
    ds_read_b64_tr_b16 v[134:135], v191 offset:33792
    ds_read_b64_tr_b16 v[136:137], v188 offset:36864
    ds_read_b64_tr_b16 v[138:139], v188 offset:37888
    ds_read_b64_tr_b16 v[140:141], v189 offset:36864
    ds_read_b64_tr_b16 v[142:143], v189 offset:37888
    ds_read_b64_tr_b16 v[144:145], v190 offset:36864
    ds_read_b64_tr_b16 v[146:147], v190 offset:37888
    ds_read_b64_tr_b16 v[148:149], v191 offset:36864
    ds_read_b64_tr_b16 v[150:151], v191 offset:37888
    s_waitcnt vmcnt(4) lgkmcnt(0)
    v_mfma_f32_32x32x16_bf16 v[32:47], v[120:123], v[152:155], v[32:47]
    v_mfma_f32_32x32x16_bf16 v[48:63], v[124:127], v[152:155], v[48:63]
    v_mfma_f32_32x32x16_bf16 v[64:79], v[128:131], v[152:155], v[64:79]
    v_mfma_f32_32x32x16_bf16 v[80:95], v[132:135], v[152:155], v[80:95]
    v_mfma_f32_32x32x16_bf16 v[32:47], v[136:139], v[156:159], v[32:47]
    v_mfma_f32_32x32x16_bf16 v[48:63], v[140:143], v[156:159], v[48:63]
    v_mfma_f32_32x32x16_bf16 v[64:79], v[144:147], v[156:159], v[64:79]
    v_mfma_f32_32x32x16_bf16 v[80:95], v[148:151], v[156:159], v[80:95]
    buffer_load_dwordx4 v[152:155], v192, s[32:35], 0 offen offset:960
    buffer_load_dwordx4 v[156:159], v192, s[32:35], 0 offen offset:992
    s_barrier
    ds_read_b64_tr_b16 v[120:121], v188 offset:40960
    ds_read_b64_tr_b16 v[122:123], v188 offset:41984
    ds_read_b64_tr_b16 v[124:125], v189 offset:40960
    ds_read_b64_tr_b16 v[126:127], v189 offset:41984
    ds_read_b64_tr_b16 v[128:129], v190 offset:40960
    ds_read_b64_tr_b16 v[130:131], v190 offset:41984
    ds_read_b64_tr_b16 v[132:133], v191 offset:40960
    ds_read_b64_tr_b16 v[134:135], v191 offset:41984
    ds_read_b64_tr_b16 v[136:137], v188 offset:45056
    ds_read_b64_tr_b16 v[138:139], v188 offset:46080
    ds_read_b64_tr_b16 v[140:141], v189 offset:45056
    ds_read_b64_tr_b16 v[142:143], v189 offset:46080
    ds_read_b64_tr_b16 v[144:145], v190 offset:45056
    ds_read_b64_tr_b16 v[146:147], v190 offset:46080
    ds_read_b64_tr_b16 v[148:149], v191 offset:45056
    ds_read_b64_tr_b16 v[150:151], v191 offset:46080
    s_waitcnt vmcnt(4) lgkmcnt(0)
    v_mfma_f32_32x32x16_bf16 v[32:47], v[120:123], v[160:163], v[32:47]
    v_mfma_f32_32x32x16_bf16 v[48:63], v[124:127], v[160:163], v[48:63]
    v_mfma_f32_32x32x16_bf16 v[64:79], v[128:131], v[160:163], v[64:79]
    v_mfma_f32_32x32x16_bf16 v[80:95], v[132:135], v[160:163], v[80:95]
    v_mfma_f32_32x32x16_bf16 v[32:47], v[136:139], v[164:167], v[32:47]
    v_mfma_f32_32x32x16_bf16 v[48:63], v[140:143], v[164:167], v[48:63]
    v_mfma_f32_32x32x16_bf16 v[64:79], v[144:147], v[164:167], v[64:79]
    v_mfma_f32_32x32x16_bf16 v[80:95], v[148:151], v[164:167], v[80:95]
    s_barrier
    ds_read_b64_tr_b16 v[120:121], v188 offset:49152
    ds_read_b64_tr_b16 v[122:123], v188 offset:50176
    ds_read_b64_tr_b16 v[124:125], v189 offset:49152
    ds_read_b64_tr_b16 v[126:127], v189 offset:50176
    ds_read_b64_tr_b16 v[128:129], v190 offset:49152
    ds_read_b64_tr_b16 v[130:131], v190 offset:50176
    ds_read_b64_tr_b16 v[132:133], v191 offset:49152
    ds_read_b64_tr_b16 v[134:135], v191 offset:50176
    ds_read_b64_tr_b16 v[136:137], v188 offset:53248
    ds_read_b64_tr_b16 v[138:139], v188 offset:54272
    ds_read_b64_tr_b16 v[140:141], v189 offset:53248
    ds_read_b64_tr_b16 v[142:143], v189 offset:54272
    ds_read_b64_tr_b16 v[144:145], v190 offset:53248
    ds_read_b64_tr_b16 v[146:147], v190 offset:54272
    ds_read_b64_tr_b16 v[148:149], v191 offset:53248
    ds_read_b64_tr_b16 v[150:151], v191 offset:54272
    s_waitcnt vmcnt(2) lgkmcnt(0)
    v_mfma_f32_32x32x16_bf16 v[32:47], v[120:123], v[168:171], v[32:47]
    v_mfma_f32_32x32x16_bf16 v[48:63], v[124:127], v[168:171], v[48:63]
    v_mfma_f32_32x32x16_bf16 v[64:79], v[128:131], v[168:171], v[64:79]
    v_mfma_f32_32x32x16_bf16 v[80:95], v[132:135], v[168:171], v[80:95]
    v_mfma_f32_32x32x16_bf16 v[32:47], v[136:139], v[172:175], v[32:47]
    v_mfma_f32_32x32x16_bf16 v[48:63], v[140:143], v[172:175], v[48:63]
    v_mfma_f32_32x32x16_bf16 v[64:79], v[144:147], v[172:175], v[64:79]
    v_mfma_f32_32x32x16_bf16 v[80:95], v[148:151], v[172:175], v[80:95]
    s_barrier
    ds_read_b64_tr_b16 v[120:121], v188 offset:57344
    ds_read_b64_tr_b16 v[122:123], v188 offset:58368
    ds_read_b64_tr_b16 v[124:125], v189 offset:57344
    ds_read_b64_tr_b16 v[126:127], v189 offset:58368
    ds_read_b64_tr_b16 v[128:129], v190 offset:57344
    ds_read_b64_tr_b16 v[130:131], v190 offset:58368
    ds_read_b64_tr_b16 v[132:133], v191 offset:57344
    ds_read_b64_tr_b16 v[134:135], v191 offset:58368
    ds_read_b64_tr_b16 v[136:137], v188 offset:61440
    ds_read_b64_tr_b16 v[138:139], v188 offset:62464
    ds_read_b64_tr_b16 v[140:141], v189 offset:61440
    ds_read_b64_tr_b16 v[142:143], v189 offset:62464
    ds_read_b64_tr_b16 v[144:145], v190 offset:61440
    ds_read_b64_tr_b16 v[146:147], v190 offset:62464
    ds_read_b64_tr_b16 v[148:149], v191 offset:61440
    ds_read_b64_tr_b16 v[150:151], v191 offset:62464
    s_waitcnt vmcnt(0) lgkmcnt(0)
    v_mfma_f32_32x32x16_bf16 v[32:47], v[120:123], v[152:155], v[32:47]
    v_mfma_f32_32x32x16_bf16 v[48:63], v[124:127], v[152:155], v[48:63]
    v_mfma_f32_32x32x16_bf16 v[64:79], v[128:131], v[152:155], v[64:79]
    v_mfma_f32_32x32x16_bf16 v[80:95], v[132:135], v[152:155], v[80:95]
    v_mfma_f32_32x32x16_bf16 v[32:47], v[136:139], v[156:159], v[32:47]
    v_mfma_f32_32x32x16_bf16 v[48:63], v[140:143], v[156:159], v[48:63]
    v_mfma_f32_32x32x16_bf16 v[64:79], v[144:147], v[156:159], v[64:79]
    v_mfma_f32_32x32x16_bf16 v[80:95], v[148:151], v[156:159], v[80:95]
    s_nop 15
    v_cvt_pk_bf16_f32 v0, v32, v33
    v_cvt_pk_bf16_f32 v1, v34, v35
    v_cvt_pk_bf16_f32 v2, v36, v37
    v_cvt_pk_bf16_f32 v3, v38, v39
    v_cvt_pk_bf16_f32 v4, v40, v41
    v_cvt_pk_bf16_f32 v5, v42, v43
    v_cvt_pk_bf16_f32 v6, v44, v45
    v_cvt_pk_bf16_f32 v7, v46, v47
    v_cvt_pk_bf16_f32 v8, v48, v49
    v_cvt_pk_bf16_f32 v9, v50, v51
    v_cvt_pk_bf16_f32 v10, v52, v53
    v_cvt_pk_bf16_f32 v11, v54, v55
    v_cvt_pk_bf16_f32 v12, v56, v57
    v_cvt_pk_bf16_f32 v13, v58, v59
    v_cvt_pk_bf16_f32 v14, v60, v61
    v_cvt_pk_bf16_f32 v15, v62, v63
    v_cvt_pk_bf16_f32 v16, v64, v65
    v_cvt_pk_bf16_f32 v17, v66, v67
    v_cvt_pk_bf16_f32 v18, v68, v69
    v_cvt_pk_bf16_f32 v19, v70, v71
    v_cvt_pk_bf16_f32 v20, v72, v73
    v_cvt_pk_bf16_f32 v21, v74, v75
    v_cvt_pk_bf16_f32 v22, v76, v77
    v_cvt_pk_bf16_f32 v23, v78, v79
    v_cvt_pk_bf16_f32 v24, v80, v81
    v_cvt_pk_bf16_f32 v25, v82, v83
    v_cvt_pk_bf16_f32 v26, v84, v85
    v_cvt_pk_bf16_f32 v27, v86, v87
    v_cvt_pk_bf16_f32 v28, v88, v89
    v_cvt_pk_bf16_f32 v29, v90, v91
    v_cvt_pk_bf16_f32 v30, v92, v93
    v_cvt_pk_bf16_f32 v31, v94, v95
    v_mov_b32 v32, 0
    v_mov_b32 v33, 0
    v_mov_b32 v34, 0
    v_mov_b32 v35, 0
    v_mov_b32 v36, 0
    v_mov_b32 v37, 0
    v_mov_b32 v38, 0
    v_mov_b32 v39, 0
    v_mov_b32 v40, 0
    v_mov_b32 v41, 0
    v_mov_b32 v42, 0
    v_mov_b32 v43, 0
    v_mov_b32 v44, 0
    v_mov_b32 v45, 0
    v_mov_b32 v46, 0
    v_mov_b32 v47, 0
    v_mov_b32 v48, 0
    v_mov_b32 v49, 0
    v_mov_b32 v50, 0
    v_mov_b32 v51, 0
    v_mov_b32 v52, 0
    v_mov_b32 v53, 0
    v_mov_b32 v54, 0
    v_mov_b32 v55, 0
    v_mov_b32 v56, 0
    v_mov_b32 v57, 0
    v_mov_b32 v58, 0
    v_mov_b32 v59, 0
    v_mov_b32 v60, 0
    v_mov_b32 v61, 0
    v_mov_b32 v62, 0
    v_mov_b32 v63, 0
    v_mov_b32 v64, 0
    v_mov_b32 v65, 0
    v_mov_b32 v66, 0
    v_mov_b32 v67, 0
    v_mov_b32 v68, 0
    v_mov_b32 v69, 0
    v_mov_b32 v70, 0
    v_mov_b32 v71, 0
    v_mov_b32 v72, 0
    v_mov_b32 v73, 0
    v_mov_b32 v74, 0
    v_mov_b32 v75, 0
    v_mov_b32 v76, 0
    v_mov_b32 v77, 0
    v_mov_b32 v78, 0
    v_mov_b32 v79, 0
    v_mov_b32 v80, 0
    v_mov_b32 v81, 0
    v_mov_b32 v82, 0
    v_mov_b32 v83, 0
    v_mov_b32 v84, 0
    v_mov_b32 v85, 0
    v_mov_b32 v86, 0
    v_mov_b32 v87, 0
    v_mov_b32 v88, 0
    v_mov_b32 v89, 0
    v_mov_b32 v90, 0
    v_mov_b32 v91, 0
    v_mov_b32 v92, 0
    v_mov_b32 v93, 0
    v_mov_b32 v94, 0
    v_mov_b32 v95, 0
    v_mov_b32 v193, 0xff800000
    v_mov_b32 v194, 0
    s_barrier
    ds_read_b128 v[120:123], v176 offset:0
    ds_read_b128 v[124:127], v177 offset:0
    ds_read_b128 v[128:131], v178 offset:0
    ds_read_b128 v[132:135], v179 offset:0
    ds_read_b128 v[136:139], v180 offset:0
    ds_read_b128 v[140:143], v181 offset:0
    ds_read_b128 v[144:147], v182 offset:0
    ds_read_b128 v[148:151], v183 offset:0
    s_waitcnt lgkmcnt(0)
    v_mfma_f32_32x32x16_bf16 v[96:111], v[120:123], v[0:3], 0
    v_mfma_f32_32x32x16_bf16 v[96:111], v[124:127], v[4:7], v[96:111]
    v_mfma_f32_32x32x16_bf16 v[96:111], v[128:131], v[8:11], v[96:111]
    v_mfma_f32_32x32x16_bf16 v[96:111], v[132:135], v[12:15], v[96:111]
    v_mfma_f32_32x32x16_bf16 v[96:111], v[136:139], v[16:19], v[96:111]
    v_mfma_f32_32x32x16_bf16 v[96:111], v[140:143], v[20:23], v[96:111]
    v_mfma_f32_32x32x16_bf16 v[96:111], v[144:147], v[24:27], v[96:111]
    v_mfma_f32_32x32x16_bf16 v[96:111], v[148:151], v[28:31], v[96:111]
    s_barrier
    ds_read_b64_tr_b16 v[120:121], v184 offset:8192
    ds_read_b64_tr_b16 v[122:123], v184 offset:10240
    ds_read_b64_tr_b16 v[124:125], v185 offset:8192
    ds_read_b64_tr_b16 v[126:127], v185 offset:10240
    ds_read_b64_tr_b16 v[128:129], v186 offset:8192
    ds_read_b64_tr_b16 v[130:131], v186 offset:10240
    ds_read_b64_tr_b16 v[132:133], v187 offset:8192
    ds_read_b64_tr_b16 v[134:135], v187 offset:10240
    ds_read_b64_tr_b16 v[136:137], v184 offset:12288
    ds_read_b64_tr_b16 v[138:139], v184 offset:14336
    ds_read_b64_tr_b16 v[140:141], v185 offset:12288
    ds_read_b64_tr_b16 v[142:143], v185 offset:14336
    ds_read_b64_tr_b16 v[144:145], v186 offset:12288
    ds_read_b64_tr_b16 v[146:147], v186 offset:14336
    ds_read_b64_tr_b16 v[148:149], v187 offset:12288
    ds_read_b64_tr_b16 v[150:151], v187 offset:14336
    s_nop 7
    v_max3_f32 v195, v96, v97, v98
    v_max3_f32 v195, v195, v99, v100
    v_max3_f32 v195, v195, v101, v102
    v_max3_f32 v195, v195, v103, v104
    v_max3_f32 v195, v195, v105, v106
    v_max3_f32 v195, v195, v107, v108
    v_max3_f32 v195, v195, v109, v110
    v_max_f32 v195, v195, v111
    v_mov_b32 v196, v195
    s_nop 1
    v_permlane32_swap_b32 v195, v196
    s_nop 1
    v_max3_f32 v195, v195, v196, v193
    v_sub_f32 v196, v193, v195
    v_mul_f32 v196, s44, v196
    v_exp_f32 v198, v196
    v_mov_b32 v193, v195
    v_mul_f32 v195, s44, v195
    v_fma_f32 v96, v96, s44, -v195
    v_fma_f32 v97, v97, s44, -v195
    v_fma_f32 v98, v98, s44, -v195
    v_fma_f32 v99, v99, s44, -v195
    v_fma_f32 v100, v100, s44, -v195
    v_fma_f32 v101, v101, s44, -v195
    v_fma_f32 v102, v102, s44, -v195
    v_fma_f32 v103, v103, s44, -v195
    v_fma_f32 v104, v104, s44, -v195
    v_fma_f32 v105, v105, s44, -v195
    v_fma_f32 v106, v106, s44, -v195
    v_fma_f32 v107, v107, s44, -v195
    v_fma_f32 v108, v108, s44, -v195
    v_fma_f32 v109, v109, s44, -v195
    v_fma_f32 v110, v110, s44, -v195
    v_fma_f32 v111, v111, s44, -v195
    v_exp_f32 v96, v96
    v_exp_f32 v97, v97
    v_exp_f32 v98, v98
    v_exp_f32 v99, v99
    v_exp_f32 v100, v100
    v_exp_f32 v101, v101
    v_exp_f32 v102, v102
    v_exp_f32 v103, v103
    v_exp_f32 v104, v104
    v_exp_f32 v105, v105
    v_exp_f32 v106, v106
    v_exp_f32 v107, v107
    v_exp_f32 v108, v108
    v_exp_f32 v109, v109
    v_exp_f32 v110, v110
    v_exp_f32 v111, v111
    v_mul_f32 v194, v194, v198
    v_add_f32 v194, v194, v96
    v_add_f32 v194, v194, v97
    v_add_f32 v194, v194, v98
    v_add_f32 v194, v194, v99
    v_add_f32 v194, v194, v100
    v_add_f32 v194, v194, v101
    v_add_f32 v194, v194, v102
    v_add_f32 v194, v194, v103
    v_add_f32 v194, v194, v104
    v_add_f32 v194, v194, v105
    v_add_f32 v194, v194, v106
    v_add_f32 v194, v194, v107
    v_add_f32 v194, v194, v108
    v_add_f32 v194, v194, v109
    v_add_f32 v194, v194, v110
    v_add_f32 v194, v194, v111
    v_cvt_pk_bf16_f32 v112, v96, v97
    v_cvt_pk_bf16_f32 v113, v98, v99
    v_cvt_pk_bf16_f32 v114, v100, v101
    v_cvt_pk_bf16_f32 v115, v102, v103
    v_cvt_pk_bf16_f32 v116, v104, v105
    v_cvt_pk_bf16_f32 v117, v106, v107
    v_cvt_pk_bf16_f32 v118, v108, v109
    v_cvt_pk_bf16_f32 v119, v110, v111
    v_mul_f32 v32, v32, v198
    v_mul_f32 v33, v33, v198
    v_mul_f32 v34, v34, v198
    v_mul_f32 v35, v35, v198
    v_mul_f32 v36, v36, v198
    v_mul_f32 v37, v37, v198
    v_mul_f32 v38, v38, v198
    v_mul_f32 v39, v39, v198
    v_mul_f32 v40, v40, v198
    v_mul_f32 v41, v41, v198
    v_mul_f32 v42, v42, v198
    v_mul_f32 v43, v43, v198
    v_mul_f32 v44, v44, v198
    v_mul_f32 v45, v45, v198
    v_mul_f32 v46, v46, v198
    v_mul_f32 v47, v47, v198
    v_mul_f32 v48, v48, v198
    v_mul_f32 v49, v49, v198
    v_mul_f32 v50, v50, v198
    v_mul_f32 v51, v51, v198
    v_mul_f32 v52, v52, v198
    v_mul_f32 v53, v53, v198
    v_mul_f32 v54, v54, v198
    v_mul_f32 v55, v55, v198
    v_mul_f32 v56, v56, v198
    v_mul_f32 v57, v57, v198
    v_mul_f32 v58, v58, v198
    v_mul_f32 v59, v59, v198
    v_mul_f32 v60, v60, v198
    v_mul_f32 v61, v61, v198
    v_mul_f32 v62, v62, v198
    v_mul_f32 v63, v63, v198
    v_mul_f32 v64, v64, v198
    v_mul_f32 v65, v65, v198
    v_mul_f32 v66, v66, v198
    v_mul_f32 v67, v67, v198
    v_mul_f32 v68, v68, v198
    v_mul_f32 v69, v69, v198
    v_mul_f32 v70, v70, v198
    v_mul_f32 v71, v71, v198
    v_mul_f32 v72, v72, v198
    v_mul_f32 v73, v73, v198
    v_mul_f32 v74, v74, v198
    v_mul_f32 v75, v75, v198
    v_mul_f32 v76, v76, v198
    v_mul_f32 v77, v77, v198
    v_mul_f32 v78, v78, v198
    v_mul_f32 v79, v79, v198
    v_mul_f32 v80, v80, v198
    v_mul_f32 v81, v81, v198
    v_mul_f32 v82, v82, v198
    v_mul_f32 v83, v83, v198
    v_mul_f32 v84, v84, v198
    v_mul_f32 v85, v85, v198
    v_mul_f32 v86, v86, v198
    v_mul_f32 v87, v87, v198
    v_mul_f32 v88, v88, v198
    v_mul_f32 v89, v89, v198
    v_mul_f32 v90, v90, v198
    v_mul_f32 v91, v91, v198
    v_mul_f32 v92, v92, v198
    v_mul_f32 v93, v93, v198
    v_mul_f32 v94, v94, v198
    v_mul_f32 v95, v95, v198
    s_waitcnt lgkmcnt(0)
    s_nop 1
    v_mfma_f32_32x32x16_bf16 v[32:47], v[120:123], v[112:115], v[32:47]
    v_mfma_f32_32x32x16_bf16 v[48:63], v[124:127], v[112:115], v[48:63]
    v_mfma_f32_32x32x16_bf16 v[64:79], v[128:131], v[112:115], v[64:79]
    v_mfma_f32_32x32x16_bf16 v[80:95], v[132:135], v[112:115], v[80:95]
    v_mfma_f32_32x32x16_bf16 v[32:47], v[136:139], v[116:119], v[32:47]
    v_mfma_f32_32x32x16_bf16 v[48:63], v[140:143], v[116:119], v[48:63]
    v_mfma_f32_32x32x16_bf16 v[64:79], v[144:147], v[116:119], v[64:79]
    v_mfma_f32_32x32x16_bf16 v[80:95], v[148:151], v[116:119], v[80:95]
    s_barrier
    ds_read_b128 v[120:123], v176 offset:16384
    ds_read_b128 v[124:127], v177 offset:16384
    ds_read_b128 v[128:131], v178 offset:16384
    ds_read_b128 v[132:135], v179 offset:16384
    ds_read_b128 v[136:139], v180 offset:16384
    ds_read_b128 v[140:143], v181 offset:16384
    ds_read_b128 v[144:147], v182 offset:16384
    ds_read_b128 v[148:151], v183 offset:16384
    s_waitcnt lgkmcnt(0)
    v_mfma_f32_32x32x16_bf16 v[96:111], v[120:123], v[0:3], 0
    v_mfma_f32_32x32x16_bf16 v[96:111], v[124:127], v[4:7], v[96:111]
    v_mfma_f32_32x32x16_bf16 v[96:111], v[128:131], v[8:11], v[96:111]
    v_mfma_f32_32x32x16_bf16 v[96:111], v[132:135], v[12:15], v[96:111]
    v_mfma_f32_32x32x16_bf16 v[96:111], v[136:139], v[16:19], v[96:111]
    v_mfma_f32_32x32x16_bf16 v[96:111], v[140:143], v[20:23], v[96:111]
    v_mfma_f32_32x32x16_bf16 v[96:111], v[144:147], v[24:27], v[96:111]
    v_mfma_f32_32x32x16_bf16 v[96:111], v[148:151], v[28:31], v[96:111]
    s_barrier
    ds_read_b64_tr_b16 v[120:121], v184 offset:24576
    ds_read_b64_tr_b16 v[122:123], v184 offset:26624
    ds_read_b64_tr_b16 v[124:125], v185 offset:24576
    ds_read_b64_tr_b16 v[126:127], v185 offset:26624
    ds_read_b64_tr_b16 v[128:129], v186 offset:24576
    ds_read_b64_tr_b16 v[130:131], v186 offset:26624
    ds_read_b64_tr_b16 v[132:133], v187 offset:24576
    ds_read_b64_tr_b16 v[134:135], v187 offset:26624
    ds_read_b64_tr_b16 v[136:137], v184 offset:28672
    ds_read_b64_tr_b16 v[138:139], v184 offset:30720
    ds_read_b64_tr_b16 v[140:141], v185 offset:28672
    ds_read_b64_tr_b16 v[142:143], v185 offset:30720
    ds_read_b64_tr_b16 v[144:145], v186 offset:28672
    ds_read_b64_tr_b16 v[146:147], v186 offset:30720
    ds_read_b64_tr_b16 v[148:149], v187 offset:28672
    ds_read_b64_tr_b16 v[150:151], v187 offset:30720
    s_nop 7
    v_max3_f32 v195, v96, v97, v98
    v_max3_f32 v195, v195, v99, v100
    v_max3_f32 v195, v195, v101, v102
    v_max3_f32 v195, v195, v103, v104
    v_max3_f32 v195, v195, v105, v106
    v_max3_f32 v195, v195, v107, v108
    v_max3_f32 v195, v195, v109, v110
    v_max_f32 v195, v195, v111
    v_mov_b32 v196, v195
    s_nop 1
    v_permlane32_swap_b32 v195, v196
    s_nop 1
    v_max3_f32 v195, v195, v196, v193
    v_sub_f32 v196, v193, v195
    v_mul_f32 v196, s44, v196
    v_exp_f32 v198, v196
    v_mov_b32 v193, v195
    v_mul_f32 v195, s44, v195
    v_fma_f32 v96, v96, s44, -v195
    v_fma_f32 v97, v97, s44, -v195
    v_fma_f32 v98, v98, s44, -v195
    v_fma_f32 v99, v99, s44, -v195
    v_fma_f32 v100, v100, s44, -v195
    v_fma_f32 v101, v101, s44, -v195
    v_fma_f32 v102, v102, s44, -v195
    v_fma_f32 v103, v103, s44, -v195
    v_fma_f32 v104, v104, s44, -v195
    v_fma_f32 v105, v105, s44, -v195
    v_fma_f32 v106, v106, s44, -v195
    v_fma_f32 v107, v107, s44, -v195
    v_fma_f32 v108, v108, s44, -v195
    v_fma_f32 v109, v109, s44, -v195
    v_fma_f32 v110, v110, s44, -v195
    v_fma_f32 v111, v111, s44, -v195
    v_exp_f32 v96, v96
    v_exp_f32 v97, v97
    v_exp_f32 v98, v98
    v_exp_f32 v99, v99
    v_exp_f32 v100, v100
    v_exp_f32 v101, v101
    v_exp_f32 v102, v102
    v_exp_f32 v103, v103
    v_exp_f32 v104, v104
    v_exp_f32 v105, v105
    v_exp_f32 v106, v106
    v_exp_f32 v107, v107
    v_exp_f32 v108, v108
    v_exp_f32 v109, v109
    v_exp_f32 v110, v110
    v_exp_f32 v111, v111
    v_mul_f32 v194, v194, v198
    v_add_f32 v194, v194, v96
    v_add_f32 v194, v194, v97
    v_add_f32 v194, v194, v98
    v_add_f32 v194, v194, v99
    v_add_f32 v194, v194, v100
    v_add_f32 v194, v194, v101
    v_add_f32 v194, v194, v102
    v_add_f32 v194, v194, v103
    v_add_f32 v194, v194, v104
    v_add_f32 v194, v194, v105
    v_add_f32 v194, v194, v106
    v_add_f32 v194, v194, v107
    v_add_f32 v194, v194, v108
    v_add_f32 v194, v194, v109
    v_add_f32 v194, v194, v110
    v_add_f32 v194, v194, v111
    v_cvt_pk_bf16_f32 v112, v96, v97
    v_cvt_pk_bf16_f32 v113, v98, v99
    v_cvt_pk_bf16_f32 v114, v100, v101
    v_cvt_pk_bf16_f32 v115, v102, v103
    v_cvt_pk_bf16_f32 v116, v104, v105
    v_cvt_pk_bf16_f32 v117, v106, v107
    v_cvt_pk_bf16_f32 v118, v108, v109
    v_cvt_pk_bf16_f32 v119, v110, v111
    v_mul_f32 v32, v32, v198
    v_mul_f32 v33, v33, v198
    v_mul_f32 v34, v34, v198
    v_mul_f32 v35, v35, v198
    v_mul_f32 v36, v36, v198
    v_mul_f32 v37, v37, v198
    v_mul_f32 v38, v38, v198
    v_mul_f32 v39, v39, v198
    v_mul_f32 v40, v40, v198
    v_mul_f32 v41, v41, v198
    v_mul_f32 v42, v42, v198
    v_mul_f32 v43, v43, v198
    v_mul_f32 v44, v44, v198
    v_mul_f32 v45, v45, v198
    v_mul_f32 v46, v46, v198
    v_mul_f32 v47, v47, v198
    v_mul_f32 v48, v48, v198
    v_mul_f32 v49, v49, v198
    v_mul_f32 v50, v50, v198
    v_mul_f32 v51, v51, v198
    v_mul_f32 v52, v52, v198
    v_mul_f32 v53, v53, v198
    v_mul_f32 v54, v54, v198
    v_mul_f32 v55, v55, v198
    v_mul_f32 v56, v56, v198
    v_mul_f32 v57, v57, v198
    v_mul_f32 v58, v58, v198
    v_mul_f32 v59, v59, v198
    v_mul_f32 v60, v60, v198
    v_mul_f32 v61, v61, v198
    v_mul_f32 v62, v62, v198
    v_mul_f32 v63, v63, v198
    v_mul_f32 v64, v64, v198
    v_mul_f32 v65, v65, v198
    v_mul_f32 v66, v66, v198
    v_mul_f32 v67, v67, v198
    v_mul_f32 v68, v68, v198
    v_mul_f32 v69, v69, v198
    v_mul_f32 v70, v70, v198
    v_mul_f32 v71, v71, v198
    v_mul_f32 v72, v72, v198
    v_mul_f32 v73, v73, v198
    v_mul_f32 v74, v74, v198
    v_mul_f32 v75, v75, v198
    v_mul_f32 v76, v76, v198
    v_mul_f32 v77, v77, v198
    v_mul_f32 v78, v78, v198
    v_mul_f32 v79, v79, v198
    v_mul_f32 v80, v80, v198
    v_mul_f32 v81, v81, v198
    v_mul_f32 v82, v82, v198
    v_mul_f32 v83, v83, v198
    v_mul_f32 v84, v84, v198
    v_mul_f32 v85, v85, v198
    v_mul_f32 v86, v86, v198
    v_mul_f32 v87, v87, v198
    v_mul_f32 v88, v88, v198
    v_mul_f32 v89, v89, v198
    v_mul_f32 v90, v90, v198
    v_mul_f32 v91, v91, v198
    v_mul_f32 v92, v92, v198
    v_mul_f32 v93, v93, v198
    v_mul_f32 v94, v94, v198
    v_mul_f32 v95, v95, v198
    s_waitcnt lgkmcnt(0)
    s_nop 1
    v_mfma_f32_32x32x16_bf16 v[32:47], v[120:123], v[112:115], v[32:47]
    v_mfma_f32_32x32x16_bf16 v[48:63], v[124:127], v[112:115], v[48:63]
    v_mfma_f32_32x32x16_bf16 v[64:79], v[128:131], v[112:115], v[64:79]
    v_mfma_f32_32x32x16_bf16 v[80:95], v[132:135], v[112:115], v[80:95]
    v_mfma_f32_32x32x16_bf16 v[32:47], v[136:139], v[116:119], v[32:47]
    v_mfma_f32_32x32x16_bf16 v[48:63], v[140:143], v[116:119], v[48:63]
    v_mfma_f32_32x32x16_bf16 v[64:79], v[144:147], v[116:119], v[64:79]
    v_mfma_f32_32x32x16_bf16 v[80:95], v[148:151], v[116:119], v[80:95]
    s_barrier
    ds_read_b128 v[120:123], v176 offset:32768
    ds_read_b128 v[124:127], v177 offset:32768
    ds_read_b128 v[128:131], v178 offset:32768
    ds_read_b128 v[132:135], v179 offset:32768
    ds_read_b128 v[136:139], v180 offset:32768
    ds_read_b128 v[140:143], v181 offset:32768
    ds_read_b128 v[144:147], v182 offset:32768
    ds_read_b128 v[148:151], v183 offset:32768
    s_waitcnt lgkmcnt(0)
    v_mfma_f32_32x32x16_bf16 v[96:111], v[120:123], v[0:3], 0
    v_mfma_f32_32x32x16_bf16 v[96:111], v[124:127], v[4:7], v[96:111]
    v_mfma_f32_32x32x16_bf16 v[96:111], v[128:131], v[8:11], v[96:111]
    v_mfma_f32_32x32x16_bf16 v[96:111], v[132:135], v[12:15], v[96:111]
    v_mfma_f32_32x32x16_bf16 v[96:111], v[136:139], v[16:19], v[96:111]
    v_mfma_f32_32x32x16_bf16 v[96:111], v[140:143], v[20:23], v[96:111]
    v_mfma_f32_32x32x16_bf16 v[96:111], v[144:147], v[24:27], v[96:111]
    v_mfma_f32_32x32x16_bf16 v[96:111], v[148:151], v[28:31], v[96:111]
    s_barrier
    ds_read_b64_tr_b16 v[120:121], v184 offset:40960
    ds_read_b64_tr_b16 v[122:123], v184 offset:43008
    ds_read_b64_tr_b16 v[124:125], v185 offset:40960
    ds_read_b64_tr_b16 v[126:127], v185 offset:43008
    ds_read_b64_tr_b16 v[128:129], v186 offset:40960
    ds_read_b64_tr_b16 v[130:131], v186 offset:43008
    ds_read_b64_tr_b16 v[132:133], v187 offset:40960
    ds_read_b64_tr_b16 v[134:135], v187 offset:43008
    ds_read_b64_tr_b16 v[136:137], v184 offset:45056
    ds_read_b64_tr_b16 v[138:139], v184 offset:47104
    ds_read_b64_tr_b16 v[140:141], v185 offset:45056
    ds_read_b64_tr_b16 v[142:143], v185 offset:47104
    ds_read_b64_tr_b16 v[144:145], v186 offset:45056
    ds_read_b64_tr_b16 v[146:147], v186 offset:47104
    ds_read_b64_tr_b16 v[148:149], v187 offset:45056
    ds_read_b64_tr_b16 v[150:151], v187 offset:47104
    s_nop 7
    v_max3_f32 v195, v96, v97, v98
    v_max3_f32 v195, v195, v99, v100
    v_max3_f32 v195, v195, v101, v102
    v_max3_f32 v195, v195, v103, v104
    v_max3_f32 v195, v195, v105, v106
    v_max3_f32 v195, v195, v107, v108
    v_max3_f32 v195, v195, v109, v110
    v_max_f32 v195, v195, v111
    v_mov_b32 v196, v195
    s_nop 1
    v_permlane32_swap_b32 v195, v196
    s_nop 1
    v_max3_f32 v195, v195, v196, v193
    v_sub_f32 v196, v193, v195
    v_mul_f32 v196, s44, v196
    v_exp_f32 v198, v196
    v_mov_b32 v193, v195
    v_mul_f32 v195, s44, v195
    v_fma_f32 v96, v96, s44, -v195
    v_fma_f32 v97, v97, s44, -v195
    v_fma_f32 v98, v98, s44, -v195
    v_fma_f32 v99, v99, s44, -v195
    v_fma_f32 v100, v100, s44, -v195
    v_fma_f32 v101, v101, s44, -v195
    v_fma_f32 v102, v102, s44, -v195
    v_fma_f32 v103, v103, s44, -v195
    v_fma_f32 v104, v104, s44, -v195
    v_fma_f32 v105, v105, s44, -v195
    v_fma_f32 v106, v106, s44, -v195
    v_fma_f32 v107, v107, s44, -v195
    v_fma_f32 v108, v108, s44, -v195
    v_fma_f32 v109, v109, s44, -v195
    v_fma_f32 v110, v110, s44, -v195
    v_fma_f32 v111, v111, s44, -v195
    v_exp_f32 v96, v96
    v_exp_f32 v97, v97
    v_exp_f32 v98, v98
    v_exp_f32 v99, v99
    v_exp_f32 v100, v100
    v_exp_f32 v101, v101
    v_exp_f32 v102, v102
    v_exp_f32 v103, v103
    v_exp_f32 v104, v104
    v_exp_f32 v105, v105
    v_exp_f32 v106, v106
    v_exp_f32 v107, v107
    v_exp_f32 v108, v108
    v_exp_f32 v109, v109
    v_exp_f32 v110, v110
    v_exp_f32 v111, v111
    v_mul_f32 v194, v194, v198
    v_add_f32 v194, v194, v96
    v_add_f32 v194, v194, v97
    v_add_f32 v194, v194, v98
    v_add_f32 v194, v194, v99
    v_add_f32 v194, v194, v100
    v_add_f32 v194, v194, v101
    v_add_f32 v194, v194, v102
    v_add_f32 v194, v194, v103
    v_add_f32 v194, v194, v104
    v_add_f32 v194, v194, v105
    v_add_f32 v194, v194, v106
    v_add_f32 v194, v194, v107
    v_add_f32 v194, v194, v108
    v_add_f32 v194, v194, v109
    v_add_f32 v194, v194, v110
    v_add_f32 v194, v194, v111
    v_cvt_pk_bf16_f32 v112, v96, v97
    v_cvt_pk_bf16_f32 v113, v98, v99
    v_cvt_pk_bf16_f32 v114, v100, v101
    v_cvt_pk_bf16_f32 v115, v102, v103
    v_cvt_pk_bf16_f32 v116, v104, v105
    v_cvt_pk_bf16_f32 v117, v106, v107
    v_cvt_pk_bf16_f32 v118, v108, v109
    v_cvt_pk_bf16_f32 v119, v110, v111
    v_mul_f32 v32, v32, v198
    v_mul_f32 v33, v33, v198
    v_mul_f32 v34, v34, v198
    v_mul_f32 v35, v35, v198
    v_mul_f32 v36, v36, v198
    v_mul_f32 v37, v37, v198
    v_mul_f32 v38, v38, v198
    v_mul_f32 v39, v39, v198
    v_mul_f32 v40, v40, v198
    v_mul_f32 v41, v41, v198
    v_mul_f32 v42, v42, v198
    v_mul_f32 v43, v43, v198
    v_mul_f32 v44, v44, v198
    v_mul_f32 v45, v45, v198
    v_mul_f32 v46, v46, v198
    v_mul_f32 v47, v47, v198
    v_mul_f32 v48, v48, v198
    v_mul_f32 v49, v49, v198
    v_mul_f32 v50, v50, v198
    v_mul_f32 v51, v51, v198
    v_mul_f32 v52, v52, v198
    v_mul_f32 v53, v53, v198
    v_mul_f32 v54, v54, v198
    v_mul_f32 v55, v55, v198
    v_mul_f32 v56, v56, v198
    v_mul_f32 v57, v57, v198
    v_mul_f32 v58, v58, v198
    v_mul_f32 v59, v59, v198
    v_mul_f32 v60, v60, v198
    v_mul_f32 v61, v61, v198
    v_mul_f32 v62, v62, v198
    v_mul_f32 v63, v63, v198
    v_mul_f32 v64, v64, v198
    v_mul_f32 v65, v65, v198
    v_mul_f32 v66, v66, v198
    v_mul_f32 v67, v67, v198
    v_mul_f32 v68, v68, v198
    v_mul_f32 v69, v69, v198
    v_mul_f32 v70, v70, v198
    v_mul_f32 v71, v71, v198
    v_mul_f32 v72, v72, v198
    v_mul_f32 v73, v73, v198
    v_mul_f32 v74, v74, v198
    v_mul_f32 v75, v75, v198
    v_mul_f32 v76, v76, v198
    v_mul_f32 v77, v77, v198
    v_mul_f32 v78, v78, v198
    v_mul_f32 v79, v79, v198
    v_mul_f32 v80, v80, v198
    v_mul_f32 v81, v81, v198
    v_mul_f32 v82, v82, v198
    v_mul_f32 v83, v83, v198
    v_mul_f32 v84, v84, v198
    v_mul_f32 v85, v85, v198
    v_mul_f32 v86, v86, v198
    v_mul_f32 v87, v87, v198
    v_mul_f32 v88, v88, v198
    v_mul_f32 v89, v89, v198
    v_mul_f32 v90, v90, v198
    v_mul_f32 v91, v91, v198
    v_mul_f32 v92, v92, v198
    v_mul_f32 v93, v93, v198
    v_mul_f32 v94, v94, v198
    v_mul_f32 v95, v95, v198
    s_waitcnt lgkmcnt(0)
    s_nop 1
    v_mfma_f32_32x32x16_bf16 v[32:47], v[120:123], v[112:115], v[32:47]
    v_mfma_f32_32x32x16_bf16 v[48:63], v[124:127], v[112:115], v[48:63]
    v_mfma_f32_32x32x16_bf16 v[64:79], v[128:131], v[112:115], v[64:79]
    v_mfma_f32_32x32x16_bf16 v[80:95], v[132:135], v[112:115], v[80:95]
    v_mfma_f32_32x32x16_bf16 v[32:47], v[136:139], v[116:119], v[32:47]
    v_mfma_f32_32x32x16_bf16 v[48:63], v[140:143], v[116:119], v[48:63]
    v_mfma_f32_32x32x16_bf16 v[64:79], v[144:147], v[116:119], v[64:79]
    v_mfma_f32_32x32x16_bf16 v[80:95], v[148:151], v[116:119], v[80:95]
    s_barrier
    ds_read_b128 v[120:123], v176 offset:49152
    ds_read_b128 v[124:127], v177 offset:49152
    ds_read_b128 v[128:131], v178 offset:49152
    ds_read_b128 v[132:135], v179 offset:49152
    ds_read_b128 v[136:139], v180 offset:49152
    ds_read_b128 v[140:143], v181 offset:49152
    ds_read_b128 v[144:147], v182 offset:49152
    ds_read_b128 v[148:151], v183 offset:49152
    s_waitcnt lgkmcnt(0)
    v_mfma_f32_32x32x16_bf16 v[96:111], v[120:123], v[0:3], 0
    v_mfma_f32_32x32x16_bf16 v[96:111], v[124:127], v[4:7], v[96:111]
    v_mfma_f32_32x32x16_bf16 v[96:111], v[128:131], v[8:11], v[96:111]
    v_mfma_f32_32x32x16_bf16 v[96:111], v[132:135], v[12:15], v[96:111]
    v_mfma_f32_32x32x16_bf16 v[96:111], v[136:139], v[16:19], v[96:111]
    v_mfma_f32_32x32x16_bf16 v[96:111], v[140:143], v[20:23], v[96:111]
    v_mfma_f32_32x32x16_bf16 v[96:111], v[144:147], v[24:27], v[96:111]
    v_mfma_f32_32x32x16_bf16 v[96:111], v[148:151], v[28:31], v[96:111]
    s_barrier
    ds_read_b64_tr_b16 v[120:121], v184 offset:57344
    ds_read_b64_tr_b16 v[122:123], v184 offset:59392
    ds_read_b64_tr_b16 v[124:125], v185 offset:57344
    ds_read_b64_tr_b16 v[126:127], v185 offset:59392
    ds_read_b64_tr_b16 v[128:129], v186 offset:57344
    ds_read_b64_tr_b16 v[130:131], v186 offset:59392
    ds_read_b64_tr_b16 v[132:133], v187 offset:57344
    ds_read_b64_tr_b16 v[134:135], v187 offset:59392
    ds_read_b64_tr_b16 v[136:137], v184 offset:61440
    ds_read_b64_tr_b16 v[138:139], v184 offset:63488
    ds_read_b64_tr_b16 v[140:141], v185 offset:61440
    ds_read_b64_tr_b16 v[142:143], v185 offset:63488
    ds_read_b64_tr_b16 v[144:145], v186 offset:61440
    ds_read_b64_tr_b16 v[146:147], v186 offset:63488
    ds_read_b64_tr_b16 v[148:149], v187 offset:61440
    ds_read_b64_tr_b16 v[150:151], v187 offset:63488
    s_nop 7
    v_max3_f32 v195, v96, v97, v98
    v_max3_f32 v195, v195, v99, v100
    v_max3_f32 v195, v195, v101, v102
    v_max3_f32 v195, v195, v103, v104
    v_max3_f32 v195, v195, v105, v106
    v_max3_f32 v195, v195, v107, v108
    v_max3_f32 v195, v195, v109, v110
    v_max_f32 v195, v195, v111
    v_mov_b32 v196, v195
    s_nop 1
    v_permlane32_swap_b32 v195, v196
    s_nop 1
    v_max3_f32 v195, v195, v196, v193
    v_sub_f32 v196, v193, v195
    v_mul_f32 v196, s44, v196
    v_exp_f32 v198, v196
    v_mov_b32 v193, v195
    v_mul_f32 v195, s44, v195
    v_fma_f32 v96, v96, s44, -v195
    v_fma_f32 v97, v97, s44, -v195
    v_fma_f32 v98, v98, s44, -v195
    v_fma_f32 v99, v99, s44, -v195
    v_fma_f32 v100, v100, s44, -v195
    v_fma_f32 v101, v101, s44, -v195
    v_fma_f32 v102, v102, s44, -v195
    v_fma_f32 v103, v103, s44, -v195
    v_fma_f32 v104, v104, s44, -v195
    v_fma_f32 v105, v105, s44, -v195
    v_fma_f32 v106, v106, s44, -v195
    v_fma_f32 v107, v107, s44, -v195
    v_fma_f32 v108, v108, s44, -v195
    v_fma_f32 v109, v109, s44, -v195
    v_fma_f32 v110, v110, s44, -v195
    v_fma_f32 v111, v111, s44, -v195
    v_exp_f32 v96, v96
    v_exp_f32 v97, v97
    v_exp_f32 v98, v98
    v_exp_f32 v99, v99
    v_exp_f32 v100, v100
    v_exp_f32 v101, v101
    v_exp_f32 v102, v102
    v_exp_f32 v103, v103
    v_exp_f32 v104, v104
    v_exp_f32 v105, v105
    v_exp_f32 v106, v106
    v_exp_f32 v107, v107
    v_exp_f32 v108, v108
    v_exp_f32 v109, v109
    v_exp_f32 v110, v110
    v_exp_f32 v111, v111
    v_mul_f32 v194, v194, v198
    v_add_f32 v194, v194, v96
    v_add_f32 v194, v194, v97
    v_add_f32 v194, v194, v98
    v_add_f32 v194, v194, v99
    v_add_f32 v194, v194, v100
    v_add_f32 v194, v194, v101
    v_add_f32 v194, v194, v102
    v_add_f32 v194, v194, v103
    v_add_f32 v194, v194, v104
    v_add_f32 v194, v194, v105
    v_add_f32 v194, v194, v106
    v_add_f32 v194, v194, v107
    v_add_f32 v194, v194, v108
    v_add_f32 v194, v194, v109
    v_add_f32 v194, v194, v110
    v_add_f32 v194, v194, v111
    v_cvt_pk_bf16_f32 v112, v96, v97
    v_cvt_pk_bf16_f32 v113, v98, v99
    v_cvt_pk_bf16_f32 v114, v100, v101
    v_cvt_pk_bf16_f32 v115, v102, v103
    v_cvt_pk_bf16_f32 v116, v104, v105
    v_cvt_pk_bf16_f32 v117, v106, v107
    v_cvt_pk_bf16_f32 v118, v108, v109
    v_cvt_pk_bf16_f32 v119, v110, v111
    v_mul_f32 v32, v32, v198
    v_mul_f32 v33, v33, v198
    v_mul_f32 v34, v34, v198
    v_mul_f32 v35, v35, v198
    v_mul_f32 v36, v36, v198
    v_mul_f32 v37, v37, v198
    v_mul_f32 v38, v38, v198
    v_mul_f32 v39, v39, v198
    v_mul_f32 v40, v40, v198
    v_mul_f32 v41, v41, v198
    v_mul_f32 v42, v42, v198
    v_mul_f32 v43, v43, v198
    v_mul_f32 v44, v44, v198
    v_mul_f32 v45, v45, v198
    v_mul_f32 v46, v46, v198
    v_mul_f32 v47, v47, v198
    v_mul_f32 v48, v48, v198
    v_mul_f32 v49, v49, v198
    v_mul_f32 v50, v50, v198
    v_mul_f32 v51, v51, v198
    v_mul_f32 v52, v52, v198
    v_mul_f32 v53, v53, v198
    v_mul_f32 v54, v54, v198
    v_mul_f32 v55, v55, v198
    v_mul_f32 v56, v56, v198
    v_mul_f32 v57, v57, v198
    v_mul_f32 v58, v58, v198
    v_mul_f32 v59, v59, v198
    v_mul_f32 v60, v60, v198
    v_mul_f32 v61, v61, v198
    v_mul_f32 v62, v62, v198
    v_mul_f32 v63, v63, v198
    v_mul_f32 v64, v64, v198
    v_mul_f32 v65, v65, v198
    v_mul_f32 v66, v66, v198
    v_mul_f32 v67, v67, v198
    v_mul_f32 v68, v68, v198
    v_mul_f32 v69, v69, v198
    v_mul_f32 v70, v70, v198
    v_mul_f32 v71, v71, v198
    v_mul_f32 v72, v72, v198
    v_mul_f32 v73, v73, v198
    v_mul_f32 v74, v74, v198
    v_mul_f32 v75, v75, v198
    v_mul_f32 v76, v76, v198
    v_mul_f32 v77, v77, v198
    v_mul_f32 v78, v78, v198
    v_mul_f32 v79, v79, v198
    v_mul_f32 v80, v80, v198
    v_mul_f32 v81, v81, v198
    v_mul_f32 v82, v82, v198
    v_mul_f32 v83, v83, v198
    v_mul_f32 v84, v84, v198
    v_mul_f32 v85, v85, v198
    v_mul_f32 v86, v86, v198
    v_mul_f32 v87, v87, v198
    v_mul_f32 v88, v88, v198
    v_mul_f32 v89, v89, v198
    v_mul_f32 v90, v90, v198
    v_mul_f32 v91, v91, v198
    v_mul_f32 v92, v92, v198
    v_mul_f32 v93, v93, v198
    v_mul_f32 v94, v94, v198
    v_mul_f32 v95, v95, v198
    s_waitcnt lgkmcnt(0)
    s_nop 1
    v_mfma_f32_32x32x16_bf16 v[32:47], v[120:123], v[112:115], v[32:47]
    v_mfma_f32_32x32x16_bf16 v[48:63], v[124:127], v[112:115], v[48:63]
    v_mfma_f32_32x32x16_bf16 v[64:79], v[128:131], v[112:115], v[64:79]
    v_mfma_f32_32x32x16_bf16 v[80:95], v[132:135], v[112:115], v[80:95]
    v_mfma_f32_32x32x16_bf16 v[32:47], v[136:139], v[116:119], v[32:47]
    v_mfma_f32_32x32x16_bf16 v[48:63], v[140:143], v[116:119], v[48:63]
    v_mfma_f32_32x32x16_bf16 v[64:79], v[144:147], v[116:119], v[64:79]
    v_mfma_f32_32x32x16_bf16 v[80:95], v[148:151], v[116:119], v[80:95]
    s_barrier
    ds_read_b128 v[120:123], v176 offset:0
    ds_read_b128 v[124:127], v177 offset:0
    ds_read_b128 v[128:131], v178 offset:0
    ds_read_b128 v[132:135], v179 offset:0
    ds_read_b128 v[136:139], v180 offset:0
    ds_read_b128 v[140:143], v181 offset:0
    ds_read_b128 v[144:147], v182 offset:0
    ds_read_b128 v[148:151], v183 offset:0
    s_waitcnt lgkmcnt(0)
    v_mfma_f32_32x32x16_bf16 v[96:111], v[120:123], v[0:3], 0
    v_mfma_f32_32x32x16_bf16 v[96:111], v[124:127], v[4:7], v[96:111]
    v_mfma_f32_32x32x16_bf16 v[96:111], v[128:131], v[8:11], v[96:111]
    v_mfma_f32_32x32x16_bf16 v[96:111], v[132:135], v[12:15], v[96:111]
    v_mfma_f32_32x32x16_bf16 v[96:111], v[136:139], v[16:19], v[96:111]
    v_mfma_f32_32x32x16_bf16 v[96:111], v[140:143], v[20:23], v[96:111]
    v_mfma_f32_32x32x16_bf16 v[96:111], v[144:147], v[24:27], v[96:111]
    v_mfma_f32_32x32x16_bf16 v[96:111], v[148:151], v[28:31], v[96:111]
    s_barrier
    ds_read_b64_tr_b16 v[120:121], v184 offset:8192
    ds_read_b64_tr_b16 v[122:123], v184 offset:10240
    ds_read_b64_tr_b16 v[124:125], v185 offset:8192
    ds_read_b64_tr_b16 v[126:127], v185 offset:10240
    ds_read_b64_tr_b16 v[128:129], v186 offset:8192
    ds_read_b64_tr_b16 v[130:131], v186 offset:10240
    ds_read_b64_tr_b16 v[132:133], v187 offset:8192
    ds_read_b64_tr_b16 v[134:135], v187 offset:10240
    ds_read_b64_tr_b16 v[136:137], v184 offset:12288
    ds_read_b64_tr_b16 v[138:139], v184 offset:14336
    ds_read_b64_tr_b16 v[140:141], v185 offset:12288
    ds_read_b64_tr_b16 v[142:143], v185 offset:14336
    ds_read_b64_tr_b16 v[144:145], v186 offset:12288
    ds_read_b64_tr_b16 v[146:147], v186 offset:14336
    ds_read_b64_tr_b16 v[148:149], v187 offset:12288
    ds_read_b64_tr_b16 v[150:151], v187 offset:14336
    s_nop 7
    v_max3_f32 v195, v96, v97, v98
    v_max3_f32 v195, v195, v99, v100
    v_max3_f32 v195, v195, v101, v102
    v_max3_f32 v195, v195, v103, v104
    v_max3_f32 v195, v195, v105, v106
    v_max3_f32 v195, v195, v107, v108
    v_max3_f32 v195, v195, v109, v110
    v_max_f32 v195, v195, v111
    v_mov_b32 v196, v195
    s_nop 1
    v_permlane32_swap_b32 v195, v196
    s_nop 1
    v_max3_f32 v195, v195, v196, v193
    v_sub_f32 v196, v193, v195
    v_mul_f32 v196, s44, v196
    v_exp_f32 v198, v196
    v_mov_b32 v193, v195
    v_mul_f32 v195, s44, v195
    v_fma_f32 v96, v96, s44, -v195
    v_fma_f32 v97, v97, s44, -v195
    v_fma_f32 v98, v98, s44, -v195
    v_fma_f32 v99, v99, s44, -v195
    v_fma_f32 v100, v100, s44, -v195
    v_fma_f32 v101, v101, s44, -v195
    v_fma_f32 v102, v102, s44, -v195
    v_fma_f32 v103, v103, s44, -v195
    v_fma_f32 v104, v104, s44, -v195
    v_fma_f32 v105, v105, s44, -v195
    v_fma_f32 v106, v106, s44, -v195
    v_fma_f32 v107, v107, s44, -v195
    v_fma_f32 v108, v108, s44, -v195
    v_fma_f32 v109, v109, s44, -v195
    v_fma_f32 v110, v110, s44, -v195
    v_fma_f32 v111, v111, s44, -v195
    v_exp_f32 v96, v96
    v_exp_f32 v97, v97
    v_exp_f32 v98, v98
    v_exp_f32 v99, v99
    v_exp_f32 v100, v100
    v_exp_f32 v101, v101
    v_exp_f32 v102, v102
    v_exp_f32 v103, v103
    v_exp_f32 v104, v104
    v_exp_f32 v105, v105
    v_exp_f32 v106, v106
    v_exp_f32 v107, v107
    v_exp_f32 v108, v108
    v_exp_f32 v109, v109
    v_exp_f32 v110, v110
    v_exp_f32 v111, v111
    v_mul_f32 v194, v194, v198
    v_add_f32 v194, v194, v96
    v_add_f32 v194, v194, v97
    v_add_f32 v194, v194, v98
    v_add_f32 v194, v194, v99
    v_add_f32 v194, v194, v100
    v_add_f32 v194, v194, v101
    v_add_f32 v194, v194, v102
    v_add_f32 v194, v194, v103
    v_add_f32 v194, v194, v104
    v_add_f32 v194, v194, v105
    v_add_f32 v194, v194, v106
    v_add_f32 v194, v194, v107
    v_add_f32 v194, v194, v108
    v_add_f32 v194, v194, v109
    v_add_f32 v194, v194, v110
    v_add_f32 v194, v194, v111
    v_cvt_pk_bf16_f32 v112, v96, v97
    v_cvt_pk_bf16_f32 v113, v98, v99
    v_cvt_pk_bf16_f32 v114, v100, v101
    v_cvt_pk_bf16_f32 v115, v102, v103
    v_cvt_pk_bf16_f32 v116, v104, v105
    v_cvt_pk_bf16_f32 v117, v106, v107
    v_cvt_pk_bf16_f32 v118, v108, v109
    v_cvt_pk_bf16_f32 v119, v110, v111
    v_mul_f32 v32, v32, v198
    v_mul_f32 v33, v33, v198
    v_mul_f32 v34, v34, v198
    v_mul_f32 v35, v35, v198
    v_mul_f32 v36, v36, v198
    v_mul_f32 v37, v37, v198
    v_mul_f32 v38, v38, v198
    v_mul_f32 v39, v39, v198
    v_mul_f32 v40, v40, v198
    v_mul_f32 v41, v41, v198
    v_mul_f32 v42, v42, v198
    v_mul_f32 v43, v43, v198
    v_mul_f32 v44, v44, v198
    v_mul_f32 v45, v45, v198
    v_mul_f32 v46, v46, v198
    v_mul_f32 v47, v47, v198
    v_mul_f32 v48, v48, v198
    v_mul_f32 v49, v49, v198
    v_mul_f32 v50, v50, v198
    v_mul_f32 v51, v51, v198
    v_mul_f32 v52, v52, v198
    v_mul_f32 v53, v53, v198
    v_mul_f32 v54, v54, v198
    v_mul_f32 v55, v55, v198
    v_mul_f32 v56, v56, v198
    v_mul_f32 v57, v57, v198
    v_mul_f32 v58, v58, v198
    v_mul_f32 v59, v59, v198
    v_mul_f32 v60, v60, v198
    v_mul_f32 v61, v61, v198
    v_mul_f32 v62, v62, v198
    v_mul_f32 v63, v63, v198
    v_mul_f32 v64, v64, v198
    v_mul_f32 v65, v65, v198
    v_mul_f32 v66, v66, v198
    v_mul_f32 v67, v67, v198
    v_mul_f32 v68, v68, v198
    v_mul_f32 v69, v69, v198
    v_mul_f32 v70, v70, v198
    v_mul_f32 v71, v71, v198
    v_mul_f32 v72, v72, v198
    v_mul_f32 v73, v73, v198
    v_mul_f32 v74, v74, v198
    v_mul_f32 v75, v75, v198
    v_mul_f32 v76, v76, v198
    v_mul_f32 v77, v77, v198
    v_mul_f32 v78, v78, v198
    v_mul_f32 v79, v79, v198
    v_mul_f32 v80, v80, v198
    v_mul_f32 v81, v81, v198
    v_mul_f32 v82, v82, v198
    v_mul_f32 v83, v83, v198
    v_mul_f32 v84, v84, v198
    v_mul_f32 v85, v85, v198
    v_mul_f32 v86, v86, v198
    v_mul_f32 v87, v87, v198
    v_mul_f32 v88, v88, v198
    v_mul_f32 v89, v89, v198
    v_mul_f32 v90, v90, v198
    v_mul_f32 v91, v91, v198
    v_mul_f32 v92, v92, v198
    v_mul_f32 v93, v93, v198
    v_mul_f32 v94, v94, v198
    v_mul_f32 v95, v95, v198
    s_waitcnt lgkmcnt(0)
    s_nop 1
    v_mfma_f32_32x32x16_bf16 v[32:47], v[120:123], v[112:115], v[32:47]
    v_mfma_f32_32x32x16_bf16 v[48:63], v[124:127], v[112:115], v[48:63]
    v_mfma_f32_32x32x16_bf16 v[64:79], v[128:131], v[112:115], v[64:79]
    v_mfma_f32_32x32x16_bf16 v[80:95], v[132:135], v[112:115], v[80:95]
    v_mfma_f32_32x32x16_bf16 v[32:47], v[136:139], v[116:119], v[32:47]
    v_mfma_f32_32x32x16_bf16 v[48:63], v[140:143], v[116:119], v[48:63]
    v_mfma_f32_32x32x16_bf16 v[64:79], v[144:147], v[116:119], v[64:79]
    v_mfma_f32_32x32x16_bf16 v[80:95], v[148:151], v[116:119], v[80:95]
    s_barrier
    ds_read_b128 v[120:123], v176 offset:16384
    ds_read_b128 v[124:127], v177 offset:16384
    ds_read_b128 v[128:131], v178 offset:16384
    ds_read_b128 v[132:135], v179 offset:16384
    ds_read_b128 v[136:139], v180 offset:16384
    ds_read_b128 v[140:143], v181 offset:16384
    ds_read_b128 v[144:147], v182 offset:16384
    ds_read_b128 v[148:151], v183 offset:16384
    s_waitcnt lgkmcnt(0)
    v_mfma_f32_32x32x16_bf16 v[96:111], v[120:123], v[0:3], 0
    v_mfma_f32_32x32x16_bf16 v[96:111], v[124:127], v[4:7], v[96:111]
    v_mfma_f32_32x32x16_bf16 v[96:111], v[128:131], v[8:11], v[96:111]
    v_mfma_f32_32x32x16_bf16 v[96:111], v[132:135], v[12:15], v[96:111]
    v_mfma_f32_32x32x16_bf16 v[96:111], v[136:139], v[16:19], v[96:111]
    v_mfma_f32_32x32x16_bf16 v[96:111], v[140:143], v[20:23], v[96:111]
    v_mfma_f32_32x32x16_bf16 v[96:111], v[144:147], v[24:27], v[96:111]
    v_mfma_f32_32x32x16_bf16 v[96:111], v[148:151], v[28:31], v[96:111]
    s_barrier
    ds_read_b64_tr_b16 v[120:121], v184 offset:24576
    ds_read_b64_tr_b16 v[122:123], v184 offset:26624
    ds_read_b64_tr_b16 v[124:125], v185 offset:24576
    ds_read_b64_tr_b16 v[126:127], v185 offset:26624
    ds_read_b64_tr_b16 v[128:129], v186 offset:24576
    ds_read_b64_tr_b16 v[130:131], v186 offset:26624
    ds_read_b64_tr_b16 v[132:133], v187 offset:24576
    ds_read_b64_tr_b16 v[134:135], v187 offset:26624
    ds_read_b64_tr_b16 v[136:137], v184 offset:28672
    ds_read_b64_tr_b16 v[138:139], v184 offset:30720
    ds_read_b64_tr_b16 v[140:141], v185 offset:28672
    ds_read_b64_tr_b16 v[142:143], v185 offset:30720
    ds_read_b64_tr_b16 v[144:145], v186 offset:28672
    ds_read_b64_tr_b16 v[146:147], v186 offset:30720
    ds_read_b64_tr_b16 v[148:149], v187 offset:28672
    ds_read_b64_tr_b16 v[150:151], v187 offset:30720
    s_nop 7
    v_max3_f32 v195, v96, v97, v98
    v_max3_f32 v195, v195, v99, v100
    v_max3_f32 v195, v195, v101, v102
    v_max3_f32 v195, v195, v103, v104
    v_max3_f32 v195, v195, v105, v106
    v_max3_f32 v195, v195, v107, v108
    v_max3_f32 v195, v195, v109, v110
    v_max_f32 v195, v195, v111
    v_mov_b32 v196, v195
    s_nop 1
    v_permlane32_swap_b32 v195, v196
    s_nop 1
    v_max3_f32 v195, v195, v196, v193
    v_sub_f32 v196, v193, v195
    v_mul_f32 v196, s44, v196
    v_exp_f32 v198, v196
    v_mov_b32 v193, v195
    v_mul_f32 v195, s44, v195
    v_fma_f32 v96, v96, s44, -v195
    v_fma_f32 v97, v97, s44, -v195
    v_fma_f32 v98, v98, s44, -v195
    v_fma_f32 v99, v99, s44, -v195
    v_fma_f32 v100, v100, s44, -v195
    v_fma_f32 v101, v101, s44, -v195
    v_fma_f32 v102, v102, s44, -v195
    v_fma_f32 v103, v103, s44, -v195
    v_fma_f32 v104, v104, s44, -v195
    v_fma_f32 v105, v105, s44, -v195
    v_fma_f32 v106, v106, s44, -v195
    v_fma_f32 v107, v107, s44, -v195
    v_fma_f32 v108, v108, s44, -v195
    v_fma_f32 v109, v109, s44, -v195
    v_fma_f32 v110, v110, s44, -v195
    v_fma_f32 v111, v111, s44, -v195
    v_exp_f32 v96, v96
    v_exp_f32 v97, v97
    v_exp_f32 v98, v98
    v_exp_f32 v99, v99
    v_exp_f32 v100, v100
    v_exp_f32 v101, v101
    v_exp_f32 v102, v102
    v_exp_f32 v103, v103
    v_exp_f32 v104, v104
    v_exp_f32 v105, v105
    v_exp_f32 v106, v106
    v_exp_f32 v107, v107
    v_exp_f32 v108, v108
    v_exp_f32 v109, v109
    v_exp_f32 v110, v110
    v_exp_f32 v111, v111
    v_mul_f32 v194, v194, v198
    v_add_f32 v194, v194, v96
    v_add_f32 v194, v194, v97
    v_add_f32 v194, v194, v98
    v_add_f32 v194, v194, v99
    v_add_f32 v194, v194, v100
    v_add_f32 v194, v194, v101
    v_add_f32 v194, v194, v102
    v_add_f32 v194, v194, v103
    v_add_f32 v194, v194, v104
    v_add_f32 v194, v194, v105
    v_add_f32 v194, v194, v106
    v_add_f32 v194, v194, v107
    v_add_f32 v194, v194, v108
    v_add_f32 v194, v194, v109
    v_add_f32 v194, v194, v110
    v_add_f32 v194, v194, v111
    v_cvt_pk_bf16_f32 v112, v96, v97
    v_cvt_pk_bf16_f32 v113, v98, v99
    v_cvt_pk_bf16_f32 v114, v100, v101
    v_cvt_pk_bf16_f32 v115, v102, v103
    v_cvt_pk_bf16_f32 v116, v104, v105
    v_cvt_pk_bf16_f32 v117, v106, v107
    v_cvt_pk_bf16_f32 v118, v108, v109
    v_cvt_pk_bf16_f32 v119, v110, v111
    v_mul_f32 v32, v32, v198
    v_mul_f32 v33, v33, v198
    v_mul_f32 v34, v34, v198
    v_mul_f32 v35, v35, v198
    v_mul_f32 v36, v36, v198
    v_mul_f32 v37, v37, v198
    v_mul_f32 v38, v38, v198
    v_mul_f32 v39, v39, v198
    v_mul_f32 v40, v40, v198
    v_mul_f32 v41, v41, v198
    v_mul_f32 v42, v42, v198
    v_mul_f32 v43, v43, v198
    v_mul_f32 v44, v44, v198
    v_mul_f32 v45, v45, v198
    v_mul_f32 v46, v46, v198
    v_mul_f32 v47, v47, v198
    v_mul_f32 v48, v48, v198
    v_mul_f32 v49, v49, v198
    v_mul_f32 v50, v50, v198
    v_mul_f32 v51, v51, v198
    v_mul_f32 v52, v52, v198
    v_mul_f32 v53, v53, v198
    v_mul_f32 v54, v54, v198
    v_mul_f32 v55, v55, v198
    v_mul_f32 v56, v56, v198
    v_mul_f32 v57, v57, v198
    v_mul_f32 v58, v58, v198
    v_mul_f32 v59, v59, v198
    v_mul_f32 v60, v60, v198
    v_mul_f32 v61, v61, v198
    v_mul_f32 v62, v62, v198
    v_mul_f32 v63, v63, v198
    v_mul_f32 v64, v64, v198
    v_mul_f32 v65, v65, v198
    v_mul_f32 v66, v66, v198
    v_mul_f32 v67, v67, v198
    v_mul_f32 v68, v68, v198
    v_mul_f32 v69, v69, v198
    v_mul_f32 v70, v70, v198
    v_mul_f32 v71, v71, v198
    v_mul_f32 v72, v72, v198
    v_mul_f32 v73, v73, v198
    v_mul_f32 v74, v74, v198
    v_mul_f32 v75, v75, v198
    v_mul_f32 v76, v76, v198
    v_mul_f32 v77, v77, v198
    v_mul_f32 v78, v78, v198
    v_mul_f32 v79, v79, v198
    v_mul_f32 v80, v80, v198
    v_mul_f32 v81, v81, v198
    v_mul_f32 v82, v82, v198
    v_mul_f32 v83, v83, v198
    v_mul_f32 v84, v84, v198
    v_mul_f32 v85, v85, v198
    v_mul_f32 v86, v86, v198
    v_mul_f32 v87, v87, v198
    v_mul_f32 v88, v88, v198
    v_mul_f32 v89, v89, v198
    v_mul_f32 v90, v90, v198
    v_mul_f32 v91, v91, v198
    v_mul_f32 v92, v92, v198
    v_mul_f32 v93, v93, v198
    v_mul_f32 v94, v94, v198
    v_mul_f32 v95, v95, v198
    s_waitcnt lgkmcnt(0)
    s_nop 1
    v_mfma_f32_32x32x16_bf16 v[32:47], v[120:123], v[112:115], v[32:47]
    v_mfma_f32_32x32x16_bf16 v[48:63], v[124:127], v[112:115], v[48:63]
    v_mfma_f32_32x32x16_bf16 v[64:79], v[128:131], v[112:115], v[64:79]
    v_mfma_f32_32x32x16_bf16 v[80:95], v[132:135], v[112:115], v[80:95]
    v_mfma_f32_32x32x16_bf16 v[32:47], v[136:139], v[116:119], v[32:47]
    v_mfma_f32_32x32x16_bf16 v[48:63], v[140:143], v[116:119], v[48:63]
    v_mfma_f32_32x32x16_bf16 v[64:79], v[144:147], v[116:119], v[64:79]
    v_mfma_f32_32x32x16_bf16 v[80:95], v[148:151], v[116:119], v[80:95]
    s_barrier
    ds_read_b128 v[120:123], v176 offset:32768
    ds_read_b128 v[124:127], v177 offset:32768
    ds_read_b128 v[128:131], v178 offset:32768
    ds_read_b128 v[132:135], v179 offset:32768
    ds_read_b128 v[136:139], v180 offset:32768
    ds_read_b128 v[140:143], v181 offset:32768
    ds_read_b128 v[144:147], v182 offset:32768
    ds_read_b128 v[148:151], v183 offset:32768
    s_waitcnt lgkmcnt(0)
    v_mfma_f32_32x32x16_bf16 v[96:111], v[120:123], v[0:3], 0
    v_mfma_f32_32x32x16_bf16 v[96:111], v[124:127], v[4:7], v[96:111]
    v_mfma_f32_32x32x16_bf16 v[96:111], v[128:131], v[8:11], v[96:111]
    v_mfma_f32_32x32x16_bf16 v[96:111], v[132:135], v[12:15], v[96:111]
    v_mfma_f32_32x32x16_bf16 v[96:111], v[136:139], v[16:19], v[96:111]
    v_mfma_f32_32x32x16_bf16 v[96:111], v[140:143], v[20:23], v[96:111]
    v_mfma_f32_32x32x16_bf16 v[96:111], v[144:147], v[24:27], v[96:111]
    v_mfma_f32_32x32x16_bf16 v[96:111], v[148:151], v[28:31], v[96:111]
    s_barrier
    ds_read_b64_tr_b16 v[120:121], v184 offset:40960
    ds_read_b64_tr_b16 v[122:123], v184 offset:43008
    ds_read_b64_tr_b16 v[124:125], v185 offset:40960
    ds_read_b64_tr_b16 v[126:127], v185 offset:43008
    ds_read_b64_tr_b16 v[128:129], v186 offset:40960
    ds_read_b64_tr_b16 v[130:131], v186 offset:43008
    ds_read_b64_tr_b16 v[132:133], v187 offset:40960
    ds_read_b64_tr_b16 v[134:135], v187 offset:43008
    ds_read_b64_tr_b16 v[136:137], v184 offset:45056
    ds_read_b64_tr_b16 v[138:139], v184 offset:47104
    ds_read_b64_tr_b16 v[140:141], v185 offset:45056
    ds_read_b64_tr_b16 v[142:143], v185 offset:47104
    ds_read_b64_tr_b16 v[144:145], v186 offset:45056
    ds_read_b64_tr_b16 v[146:147], v186 offset:47104
    ds_read_b64_tr_b16 v[148:149], v187 offset:45056
    ds_read_b64_tr_b16 v[150:151], v187 offset:47104
    s_nop 7
    v_max3_f32 v195, v96, v97, v98
    v_max3_f32 v195, v195, v99, v100
    v_max3_f32 v195, v195, v101, v102
    v_max3_f32 v195, v195, v103, v104
    v_max3_f32 v195, v195, v105, v106
    v_max3_f32 v195, v195, v107, v108
    v_max3_f32 v195, v195, v109, v110
    v_max_f32 v195, v195, v111
    v_mov_b32 v196, v195
    s_nop 1
    v_permlane32_swap_b32 v195, v196
    s_nop 1
    v_max3_f32 v195, v195, v196, v193
    v_sub_f32 v196, v193, v195
    v_mul_f32 v196, s44, v196
    v_exp_f32 v198, v196
    v_mov_b32 v193, v195
    v_mul_f32 v195, s44, v195
    v_fma_f32 v96, v96, s44, -v195
    v_fma_f32 v97, v97, s44, -v195
    v_fma_f32 v98, v98, s44, -v195
    v_fma_f32 v99, v99, s44, -v195
    v_fma_f32 v100, v100, s44, -v195
    v_fma_f32 v101, v101, s44, -v195
    v_fma_f32 v102, v102, s44, -v195
    v_fma_f32 v103, v103, s44, -v195
    v_fma_f32 v104, v104, s44, -v195
    v_fma_f32 v105, v105, s44, -v195
    v_fma_f32 v106, v106, s44, -v195
    v_fma_f32 v107, v107, s44, -v195
    v_fma_f32 v108, v108, s44, -v195
    v_fma_f32 v109, v109, s44, -v195
    v_fma_f32 v110, v110, s44, -v195
    v_fma_f32 v111, v111, s44, -v195
    v_exp_f32 v96, v96
    v_exp_f32 v97, v97
    v_exp_f32 v98, v98
    v_exp_f32 v99, v99
    v_exp_f32 v100, v100
    v_exp_f32 v101, v101
    v_exp_f32 v102, v102
    v_exp_f32 v103, v103
    v_exp_f32 v104, v104
    v_exp_f32 v105, v105
    v_exp_f32 v106, v106
    v_exp_f32 v107, v107
    v_exp_f32 v108, v108
    v_exp_f32 v109, v109
    v_exp_f32 v110, v110
    v_exp_f32 v111, v111
    v_mul_f32 v194, v194, v198
    v_add_f32 v194, v194, v96
    v_add_f32 v194, v194, v97
    v_add_f32 v194, v194, v98
    v_add_f32 v194, v194, v99
    v_add_f32 v194, v194, v100
    v_add_f32 v194, v194, v101
    v_add_f32 v194, v194, v102
    v_add_f32 v194, v194, v103
    v_add_f32 v194, v194, v104
    v_add_f32 v194, v194, v105
    v_add_f32 v194, v194, v106
    v_add_f32 v194, v194, v107
    v_add_f32 v194, v194, v108
    v_add_f32 v194, v194, v109
    v_add_f32 v194, v194, v110
    v_add_f32 v194, v194, v111
    v_cvt_pk_bf16_f32 v112, v96, v97
    v_cvt_pk_bf16_f32 v113, v98, v99
    v_cvt_pk_bf16_f32 v114, v100, v101
    v_cvt_pk_bf16_f32 v115, v102, v103
    v_cvt_pk_bf16_f32 v116, v104, v105
    v_cvt_pk_bf16_f32 v117, v106, v107
    v_cvt_pk_bf16_f32 v118, v108, v109
    v_cvt_pk_bf16_f32 v119, v110, v111
    v_mul_f32 v32, v32, v198
    v_mul_f32 v33, v33, v198
    v_mul_f32 v34, v34, v198
    v_mul_f32 v35, v35, v198
    v_mul_f32 v36, v36, v198
    v_mul_f32 v37, v37, v198
    v_mul_f32 v38, v38, v198
    v_mul_f32 v39, v39, v198
    v_mul_f32 v40, v40, v198
    v_mul_f32 v41, v41, v198
    v_mul_f32 v42, v42, v198
    v_mul_f32 v43, v43, v198
    v_mul_f32 v44, v44, v198
    v_mul_f32 v45, v45, v198
    v_mul_f32 v46, v46, v198
    v_mul_f32 v47, v47, v198
    v_mul_f32 v48, v48, v198
    v_mul_f32 v49, v49, v198
    v_mul_f32 v50, v50, v198
    v_mul_f32 v51, v51, v198
    v_mul_f32 v52, v52, v198
    v_mul_f32 v53, v53, v198
    v_mul_f32 v54, v54, v198
    v_mul_f32 v55, v55, v198
    v_mul_f32 v56, v56, v198
    v_mul_f32 v57, v57, v198
    v_mul_f32 v58, v58, v198
    v_mul_f32 v59, v59, v198
    v_mul_f32 v60, v60, v198
    v_mul_f32 v61, v61, v198
    v_mul_f32 v62, v62, v198
    v_mul_f32 v63, v63, v198
    v_mul_f32 v64, v64, v198
    v_mul_f32 v65, v65, v198
    v_mul_f32 v66, v66, v198
    v_mul_f32 v67, v67, v198
    v_mul_f32 v68, v68, v198
    v_mul_f32 v69, v69, v198
    v_mul_f32 v70, v70, v198
    v_mul_f32 v71, v71, v198
    v_mul_f32 v72, v72, v198
    v_mul_f32 v73, v73, v198
    v_mul_f32 v74, v74, v198
    v_mul_f32 v75, v75, v198
    v_mul_f32 v76, v76, v198
    v_mul_f32 v77, v77, v198
    v_mul_f32 v78, v78, v198
    v_mul_f32 v79, v79, v198
    v_mul_f32 v80, v80, v198
    v_mul_f32 v81, v81, v198
    v_mul_f32 v82, v82, v198
    v_mul_f32 v83, v83, v198
    v_mul_f32 v84, v84, v198
    v_mul_f32 v85, v85, v198
    v_mul_f32 v86, v86, v198
    v_mul_f32 v87, v87, v198
    v_mul_f32 v88, v88, v198
    v_mul_f32 v89, v89, v198
    v_mul_f32 v90, v90, v198
    v_mul_f32 v91, v91, v198
    v_mul_f32 v92, v92, v198
    v_mul_f32 v93, v93, v198
    v_mul_f32 v94, v94, v198
    v_mul_f32 v95, v95, v198
    s_waitcnt lgkmcnt(0)
    s_nop 1
    v_mfma_f32_32x32x16_bf16 v[32:47], v[120:123], v[112:115], v[32:47]
    v_mfma_f32_32x32x16_bf16 v[48:63], v[124:127], v[112:115], v[48:63]
    v_mfma_f32_32x32x16_bf16 v[64:79], v[128:131], v[112:115], v[64:79]
    v_mfma_f32_32x32x16_bf16 v[80:95], v[132:135], v[112:115], v[80:95]
    v_mfma_f32_32x32x16_bf16 v[32:47], v[136:139], v[116:119], v[32:47]
    v_mfma_f32_32x32x16_bf16 v[48:63], v[140:143], v[116:119], v[48:63]
    v_mfma_f32_32x32x16_bf16 v[64:79], v[144:147], v[116:119], v[64:79]
    v_mfma_f32_32x32x16_bf16 v[80:95], v[148:151], v[116:119], v[80:95]
    s_barrier
    ds_read_b128 v[120:123], v176 offset:49152
    ds_read_b128 v[124:127], v177 offset:49152
    ds_read_b128 v[128:131], v178 offset:49152
    ds_read_b128 v[132:135], v179 offset:49152
    ds_read_b128 v[136:139], v180 offset:49152
    ds_read_b128 v[140:143], v181 offset:49152
    ds_read_b128 v[144:147], v182 offset:49152
    ds_read_b128 v[148:151], v183 offset:49152
    s_waitcnt lgkmcnt(0)
    v_mfma_f32_32x32x16_bf16 v[96:111], v[120:123], v[0:3], 0
    v_mfma_f32_32x32x16_bf16 v[96:111], v[124:127], v[4:7], v[96:111]
    v_mfma_f32_32x32x16_bf16 v[96:111], v[128:131], v[8:11], v[96:111]
    v_mfma_f32_32x32x16_bf16 v[96:111], v[132:135], v[12:15], v[96:111]
    v_mfma_f32_32x32x16_bf16 v[96:111], v[136:139], v[16:19], v[96:111]
    v_mfma_f32_32x32x16_bf16 v[96:111], v[140:143], v[20:23], v[96:111]
    v_mfma_f32_32x32x16_bf16 v[96:111], v[144:147], v[24:27], v[96:111]
    v_mfma_f32_32x32x16_bf16 v[96:111], v[148:151], v[28:31], v[96:111]
    s_barrier
    ds_read_b64_tr_b16 v[120:121], v184 offset:57344
    ds_read_b64_tr_b16 v[122:123], v184 offset:59392
    ds_read_b64_tr_b16 v[124:125], v185 offset:57344
    ds_read_b64_tr_b16 v[126:127], v185 offset:59392
    ds_read_b64_tr_b16 v[128:129], v186 offset:57344
    ds_read_b64_tr_b16 v[130:131], v186 offset:59392
    ds_read_b64_tr_b16 v[132:133], v187 offset:57344
    ds_read_b64_tr_b16 v[134:135], v187 offset:59392
    ds_read_b64_tr_b16 v[136:137], v184 offset:61440
    ds_read_b64_tr_b16 v[138:139], v184 offset:63488
    ds_read_b64_tr_b16 v[140:141], v185 offset:61440
    ds_read_b64_tr_b16 v[142:143], v185 offset:63488
    ds_read_b64_tr_b16 v[144:145], v186 offset:61440
    ds_read_b64_tr_b16 v[146:147], v186 offset:63488
    ds_read_b64_tr_b16 v[148:149], v187 offset:61440
    ds_read_b64_tr_b16 v[150:151], v187 offset:63488
    s_nop 7
    v_max3_f32 v195, v96, v97, v98
    v_max3_f32 v195, v195, v99, v100
    v_max3_f32 v195, v195, v101, v102
    v_max3_f32 v195, v195, v103, v104
    v_max3_f32 v195, v195, v105, v106
    v_max3_f32 v195, v195, v107, v108
    v_max3_f32 v195, v195, v109, v110
    v_max_f32 v195, v195, v111
    v_mov_b32 v196, v195
    s_nop 1
    v_permlane32_swap_b32 v195, v196
    s_nop 1
    v_max3_f32 v195, v195, v196, v193
    v_sub_f32 v196, v193, v195
    v_mul_f32 v196, s44, v196
    v_exp_f32 v198, v196
    v_mov_b32 v193, v195
    v_mul_f32 v195, s44, v195
    v_fma_f32 v96, v96, s44, -v195
    v_fma_f32 v97, v97, s44, -v195
    v_fma_f32 v98, v98, s44, -v195
    v_fma_f32 v99, v99, s44, -v195
    v_fma_f32 v100, v100, s44, -v195
    v_fma_f32 v101, v101, s44, -v195
    v_fma_f32 v102, v102, s44, -v195
    v_fma_f32 v103, v103, s44, -v195
    v_fma_f32 v104, v104, s44, -v195
    v_fma_f32 v105, v105, s44, -v195
    v_fma_f32 v106, v106, s44, -v195
    v_fma_f32 v107, v107, s44, -v195
    v_fma_f32 v108, v108, s44, -v195
    v_fma_f32 v109, v109, s44, -v195
    v_fma_f32 v110, v110, s44, -v195
    v_fma_f32 v111, v111, s44, -v195
    v_exp_f32 v96, v96
    v_exp_f32 v97, v97
    v_exp_f32 v98, v98
    v_exp_f32 v99, v99
    v_exp_f32 v100, v100
    v_exp_f32 v101, v101
    v_exp_f32 v102, v102
    v_exp_f32 v103, v103
    v_exp_f32 v104, v104
    v_exp_f32 v105, v105
    v_exp_f32 v106, v106
    v_exp_f32 v107, v107
    v_exp_f32 v108, v108
    v_exp_f32 v109, v109
    v_exp_f32 v110, v110
    v_exp_f32 v111, v111
    v_mul_f32 v194, v194, v198
    v_add_f32 v194, v194, v96
    v_add_f32 v194, v194, v97
    v_add_f32 v194, v194, v98
    v_add_f32 v194, v194, v99
    v_add_f32 v194, v194, v100
    v_add_f32 v194, v194, v101
    v_add_f32 v194, v194, v102
    v_add_f32 v194, v194, v103
    v_add_f32 v194, v194, v104
    v_add_f32 v194, v194, v105
    v_add_f32 v194, v194, v106
    v_add_f32 v194, v194, v107
    v_add_f32 v194, v194, v108
    v_add_f32 v194, v194, v109
    v_add_f32 v194, v194, v110
    v_add_f32 v194, v194, v111
    v_cvt_pk_bf16_f32 v112, v96, v97
    v_cvt_pk_bf16_f32 v113, v98, v99
    v_cvt_pk_bf16_f32 v114, v100, v101
    v_cvt_pk_bf16_f32 v115, v102, v103
    v_cvt_pk_bf16_f32 v116, v104, v105
    v_cvt_pk_bf16_f32 v117, v106, v107
    v_cvt_pk_bf16_f32 v118, v108, v109
    v_cvt_pk_bf16_f32 v119, v110, v111
    v_mul_f32 v32, v32, v198
    v_mul_f32 v33, v33, v198
    v_mul_f32 v34, v34, v198
    v_mul_f32 v35, v35, v198
    v_mul_f32 v36, v36, v198
    v_mul_f32 v37, v37, v198
    v_mul_f32 v38, v38, v198
    v_mul_f32 v39, v39, v198
    v_mul_f32 v40, v40, v198
    v_mul_f32 v41, v41, v198
    v_mul_f32 v42, v42, v198
    v_mul_f32 v43, v43, v198
    v_mul_f32 v44, v44, v198
    v_mul_f32 v45, v45, v198
    v_mul_f32 v46, v46, v198
    v_mul_f32 v47, v47, v198
    v_mul_f32 v48, v48, v198
    v_mul_f32 v49, v49, v198
    v_mul_f32 v50, v50, v198
    v_mul_f32 v51, v51, v198
    v_mul_f32 v52, v52, v198
    v_mul_f32 v53, v53, v198
    v_mul_f32 v54, v54, v198
    v_mul_f32 v55, v55, v198
    v_mul_f32 v56, v56, v198
    v_mul_f32 v57, v57, v198
    v_mul_f32 v58, v58, v198
    v_mul_f32 v59, v59, v198
    v_mul_f32 v60, v60, v198
    v_mul_f32 v61, v61, v198
    v_mul_f32 v62, v62, v198
    v_mul_f32 v63, v63, v198
    v_mul_f32 v64, v64, v198
    v_mul_f32 v65, v65, v198
    v_mul_f32 v66, v66, v198
    v_mul_f32 v67, v67, v198
    v_mul_f32 v68, v68, v198
    v_mul_f32 v69, v69, v198
    v_mul_f32 v70, v70, v198
    v_mul_f32 v71, v71, v198
    v_mul_f32 v72, v72, v198
    v_mul_f32 v73, v73, v198
    v_mul_f32 v74, v74, v198
    v_mul_f32 v75, v75, v198
    v_mul_f32 v76, v76, v198
    v_mul_f32 v77, v77, v198
    v_mul_f32 v78, v78, v198
    v_mul_f32 v79, v79, v198
    v_mul_f32 v80, v80, v198
    v_mul_f32 v81, v81, v198
    v_mul_f32 v82, v82, v198
    v_mul_f32 v83, v83, v198
    v_mul_f32 v84, v84, v198
    v_mul_f32 v85, v85, v198
    v_mul_f32 v86, v86, v198
    v_mul_f32 v87, v87, v198
    v_mul_f32 v88, v88, v198
    v_mul_f32 v89, v89, v198
    v_mul_f32 v90, v90, v198
    v_mul_f32 v91, v91, v198
    v_mul_f32 v92, v92, v198
    v_mul_f32 v93, v93, v198
    v_mul_f32 v94, v94, v198
    v_mul_f32 v95, v95, v198
    s_waitcnt lgkmcnt(0)
    s_nop 1
    v_mfma_f32_32x32x16_bf16 v[32:47], v[120:123], v[112:115], v[32:47]
    v_mfma_f32_32x32x16_bf16 v[48:63], v[124:127], v[112:115], v[48:63]
    v_mfma_f32_32x32x16_bf16 v[64:79], v[128:131], v[112:115], v[64:79]
    v_mfma_f32_32x32x16_bf16 v[80:95], v[132:135], v[112:115], v[80:95]
    v_mfma_f32_32x32x16_bf16 v[32:47], v[136:139], v[116:119], v[32:47]
    v_mfma_f32_32x32x16_bf16 v[48:63], v[140:143], v[116:119], v[48:63]
    v_mfma_f32_32x32x16_bf16 v[64:79], v[144:147], v[116:119], v[64:79]
    v_mfma_f32_32x32x16_bf16 v[80:95], v[148:151], v[116:119], v[80:95]
    s_barrier
    ds_read_b128 v[120:123], v176 offset:0
    ds_read_b128 v[124:127], v177 offset:0
    ds_read_b128 v[128:131], v178 offset:0
    ds_read_b128 v[132:135], v179 offset:0
    ds_read_b128 v[136:139], v180 offset:0
    ds_read_b128 v[140:143], v181 offset:0
    ds_read_b128 v[144:147], v182 offset:0
    ds_read_b128 v[148:151], v183 offset:0
    s_waitcnt lgkmcnt(0)
    v_mfma_f32_32x32x16_bf16 v[96:111], v[120:123], v[0:3], 0
    v_mfma_f32_32x32x16_bf16 v[96:111], v[124:127], v[4:7], v[96:111]
    v_mfma_f32_32x32x16_bf16 v[96:111], v[128:131], v[8:11], v[96:111]
    v_mfma_f32_32x32x16_bf16 v[96:111], v[132:135], v[12:15], v[96:111]
    v_mfma_f32_32x32x16_bf16 v[96:111], v[136:139], v[16:19], v[96:111]
    v_mfma_f32_32x32x16_bf16 v[96:111], v[140:143], v[20:23], v[96:111]
    v_mfma_f32_32x32x16_bf16 v[96:111], v[144:147], v[24:27], v[96:111]
    v_mfma_f32_32x32x16_bf16 v[96:111], v[148:151], v[28:31], v[96:111]
    s_barrier
    ds_read_b64_tr_b16 v[120:121], v184 offset:8192
    ds_read_b64_tr_b16 v[122:123], v184 offset:10240
    ds_read_b64_tr_b16 v[124:125], v185 offset:8192
    ds_read_b64_tr_b16 v[126:127], v185 offset:10240
    ds_read_b64_tr_b16 v[128:129], v186 offset:8192
    ds_read_b64_tr_b16 v[130:131], v186 offset:10240
    ds_read_b64_tr_b16 v[132:133], v187 offset:8192
    ds_read_b64_tr_b16 v[134:135], v187 offset:10240
    ds_read_b64_tr_b16 v[136:137], v184 offset:12288
    ds_read_b64_tr_b16 v[138:139], v184 offset:14336
    ds_read_b64_tr_b16 v[140:141], v185 offset:12288
    ds_read_b64_tr_b16 v[142:143], v185 offset:14336
    ds_read_b64_tr_b16 v[144:145], v186 offset:12288
    ds_read_b64_tr_b16 v[146:147], v186 offset:14336
    ds_read_b64_tr_b16 v[148:149], v187 offset:12288
    ds_read_b64_tr_b16 v[150:151], v187 offset:14336
    s_nop 7
    v_max3_f32 v195, v96, v97, v98
    v_max3_f32 v195, v195, v99, v100
    v_max3_f32 v195, v195, v101, v102
    v_max3_f32 v195, v195, v103, v104
    v_max3_f32 v195, v195, v105, v106
    v_max3_f32 v195, v195, v107, v108
    v_max3_f32 v195, v195, v109, v110
    v_max_f32 v195, v195, v111
    v_mov_b32 v196, v195
    s_nop 1
    v_permlane32_swap_b32 v195, v196
    s_nop 1
    v_max3_f32 v195, v195, v196, v193
    v_sub_f32 v196, v193, v195
    v_mul_f32 v196, s44, v196
    v_exp_f32 v198, v196
    v_mov_b32 v193, v195
    v_mul_f32 v195, s44, v195
    v_fma_f32 v96, v96, s44, -v195
    v_fma_f32 v97, v97, s44, -v195
    v_fma_f32 v98, v98, s44, -v195
    v_fma_f32 v99, v99, s44, -v195
    v_fma_f32 v100, v100, s44, -v195
    v_fma_f32 v101, v101, s44, -v195
    v_fma_f32 v102, v102, s44, -v195
    v_fma_f32 v103, v103, s44, -v195
    v_fma_f32 v104, v104, s44, -v195
    v_fma_f32 v105, v105, s44, -v195
    v_fma_f32 v106, v106, s44, -v195
    v_fma_f32 v107, v107, s44, -v195
    v_fma_f32 v108, v108, s44, -v195
    v_fma_f32 v109, v109, s44, -v195
    v_fma_f32 v110, v110, s44, -v195
    v_fma_f32 v111, v111, s44, -v195
    v_exp_f32 v96, v96
    v_exp_f32 v97, v97
    v_exp_f32 v98, v98
    v_exp_f32 v99, v99
    v_exp_f32 v100, v100
    v_exp_f32 v101, v101
    v_exp_f32 v102, v102
    v_exp_f32 v103, v103
    v_exp_f32 v104, v104
    v_exp_f32 v105, v105
    v_exp_f32 v106, v106
    v_exp_f32 v107, v107
    v_exp_f32 v108, v108
    v_exp_f32 v109, v109
    v_exp_f32 v110, v110
    v_exp_f32 v111, v111
    v_mul_f32 v194, v194, v198
    v_add_f32 v194, v194, v96
    v_add_f32 v194, v194, v97
    v_add_f32 v194, v194, v98
    v_add_f32 v194, v194, v99
    v_add_f32 v194, v194, v100
    v_add_f32 v194, v194, v101
    v_add_f32 v194, v194, v102
    v_add_f32 v194, v194, v103
    v_add_f32 v194, v194, v104
    v_add_f32 v194, v194, v105
    v_add_f32 v194, v194, v106
    v_add_f32 v194, v194, v107
    v_add_f32 v194, v194, v108
    v_add_f32 v194, v194, v109
    v_add_f32 v194, v194, v110
    v_add_f32 v194, v194, v111
    v_cvt_pk_bf16_f32 v112, v96, v97
    v_cvt_pk_bf16_f32 v113, v98, v99
    v_cvt_pk_bf16_f32 v114, v100, v101
    v_cvt_pk_bf16_f32 v115, v102, v103
    v_cvt_pk_bf16_f32 v116, v104, v105
    v_cvt_pk_bf16_f32 v117, v106, v107
    v_cvt_pk_bf16_f32 v118, v108, v109
    v_cvt_pk_bf16_f32 v119, v110, v111
    v_mul_f32 v32, v32, v198
    v_mul_f32 v33, v33, v198
    v_mul_f32 v34, v34, v198
    v_mul_f32 v35, v35, v198
    v_mul_f32 v36, v36, v198
    v_mul_f32 v37, v37, v198
    v_mul_f32 v38, v38, v198
    v_mul_f32 v39, v39, v198
    v_mul_f32 v40, v40, v198
    v_mul_f32 v41, v41, v198
    v_mul_f32 v42, v42, v198
    v_mul_f32 v43, v43, v198
    v_mul_f32 v44, v44, v198
    v_mul_f32 v45, v45, v198
    v_mul_f32 v46, v46, v198
    v_mul_f32 v47, v47, v198
    v_mul_f32 v48, v48, v198
    v_mul_f32 v49, v49, v198
    v_mul_f32 v50, v50, v198
    v_mul_f32 v51, v51, v198
    v_mul_f32 v52, v52, v198
    v_mul_f32 v53, v53, v198
    v_mul_f32 v54, v54, v198
    v_mul_f32 v55, v55, v198
    v_mul_f32 v56, v56, v198
    v_mul_f32 v57, v57, v198
    v_mul_f32 v58, v58, v198
    v_mul_f32 v59, v59, v198
    v_mul_f32 v60, v60, v198
    v_mul_f32 v61, v61, v198
    v_mul_f32 v62, v62, v198
    v_mul_f32 v63, v63, v198
    v_mul_f32 v64, v64, v198
    v_mul_f32 v65, v65, v198
    v_mul_f32 v66, v66, v198
    v_mul_f32 v67, v67, v198
    v_mul_f32 v68, v68, v198
    v_mul_f32 v69, v69, v198
    v_mul_f32 v70, v70, v198
    v_mul_f32 v71, v71, v198
    v_mul_f32 v72, v72, v198
    v_mul_f32 v73, v73, v198
    v_mul_f32 v74, v74, v198
    v_mul_f32 v75, v75, v198
    v_mul_f32 v76, v76, v198
    v_mul_f32 v77, v77, v198
    v_mul_f32 v78, v78, v198
    v_mul_f32 v79, v79, v198
    v_mul_f32 v80, v80, v198
    v_mul_f32 v81, v81, v198
    v_mul_f32 v82, v82, v198
    v_mul_f32 v83, v83, v198
    v_mul_f32 v84, v84, v198
    v_mul_f32 v85, v85, v198
    v_mul_f32 v86, v86, v198
    v_mul_f32 v87, v87, v198
    v_mul_f32 v88, v88, v198
    v_mul_f32 v89, v89, v198
    v_mul_f32 v90, v90, v198
    v_mul_f32 v91, v91, v198
    v_mul_f32 v92, v92, v198
    v_mul_f32 v93, v93, v198
    v_mul_f32 v94, v94, v198
    v_mul_f32 v95, v95, v198
    s_waitcnt lgkmcnt(0)
    s_nop 1
    v_mfma_f32_32x32x16_bf16 v[32:47], v[120:123], v[112:115], v[32:47]
    v_mfma_f32_32x32x16_bf16 v[48:63], v[124:127], v[112:115], v[48:63]
    v_mfma_f32_32x32x16_bf16 v[64:79], v[128:131], v[112:115], v[64:79]
    v_mfma_f32_32x32x16_bf16 v[80:95], v[132:135], v[112:115], v[80:95]
    v_mfma_f32_32x32x16_bf16 v[32:47], v[136:139], v[116:119], v[32:47]
    v_mfma_f32_32x32x16_bf16 v[48:63], v[140:143], v[116:119], v[48:63]
    v_mfma_f32_32x32x16_bf16 v[64:79], v[144:147], v[116:119], v[64:79]
    v_mfma_f32_32x32x16_bf16 v[80:95], v[148:151], v[116:119], v[80:95]
    s_barrier
    ds_read_b128 v[120:123], v176 offset:16384
    ds_read_b128 v[124:127], v177 offset:16384
    ds_read_b128 v[128:131], v178 offset:16384
    ds_read_b128 v[132:135], v179 offset:16384
    ds_read_b128 v[136:139], v180 offset:16384
    ds_read_b128 v[140:143], v181 offset:16384
    ds_read_b128 v[144:147], v182 offset:16384
    ds_read_b128 v[148:151], v183 offset:16384
    s_waitcnt lgkmcnt(0)
    v_mfma_f32_32x32x16_bf16 v[96:111], v[120:123], v[0:3], 0
    v_mfma_f32_32x32x16_bf16 v[96:111], v[124:127], v[4:7], v[96:111]
    v_mfma_f32_32x32x16_bf16 v[96:111], v[128:131], v[8:11], v[96:111]
    v_mfma_f32_32x32x16_bf16 v[96:111], v[132:135], v[12:15], v[96:111]
    v_mfma_f32_32x32x16_bf16 v[96:111], v[136:139], v[16:19], v[96:111]
    v_mfma_f32_32x32x16_bf16 v[96:111], v[140:143], v[20:23], v[96:111]
    v_mfma_f32_32x32x16_bf16 v[96:111], v[144:147], v[24:27], v[96:111]
    v_mfma_f32_32x32x16_bf16 v[96:111], v[148:151], v[28:31], v[96:111]
    s_barrier
    ds_read_b64_tr_b16 v[120:121], v184 offset:24576
    ds_read_b64_tr_b16 v[122:123], v184 offset:26624
    ds_read_b64_tr_b16 v[124:125], v185 offset:24576
    ds_read_b64_tr_b16 v[126:127], v185 offset:26624
    ds_read_b64_tr_b16 v[128:129], v186 offset:24576
    ds_read_b64_tr_b16 v[130:131], v186 offset:26624
    ds_read_b64_tr_b16 v[132:133], v187 offset:24576
    ds_read_b64_tr_b16 v[134:135], v187 offset:26624
    ds_read_b64_tr_b16 v[136:137], v184 offset:28672
    ds_read_b64_tr_b16 v[138:139], v184 offset:30720
    ds_read_b64_tr_b16 v[140:141], v185 offset:28672
    ds_read_b64_tr_b16 v[142:143], v185 offset:30720
    ds_read_b64_tr_b16 v[144:145], v186 offset:28672
    ds_read_b64_tr_b16 v[146:147], v186 offset:30720
    ds_read_b64_tr_b16 v[148:149], v187 offset:28672
    ds_read_b64_tr_b16 v[150:151], v187 offset:30720
    s_nop 7
    v_max3_f32 v195, v96, v97, v98
    v_max3_f32 v195, v195, v99, v100
    v_max3_f32 v195, v195, v101, v102
    v_max3_f32 v195, v195, v103, v104
    v_max3_f32 v195, v195, v105, v106
    v_max3_f32 v195, v195, v107, v108
    v_max3_f32 v195, v195, v109, v110
    v_max_f32 v195, v195, v111
    v_mov_b32 v196, v195
    s_nop 1
    v_permlane32_swap_b32 v195, v196
    s_nop 1
    v_max3_f32 v195, v195, v196, v193
    v_sub_f32 v196, v193, v195
    v_mul_f32 v196, s44, v196
    v_exp_f32 v198, v196
    v_mov_b32 v193, v195
    v_mul_f32 v195, s44, v195
    v_fma_f32 v96, v96, s44, -v195
    v_fma_f32 v97, v97, s44, -v195
    v_fma_f32 v98, v98, s44, -v195
    v_fma_f32 v99, v99, s44, -v195
    v_fma_f32 v100, v100, s44, -v195
    v_fma_f32 v101, v101, s44, -v195
    v_fma_f32 v102, v102, s44, -v195
    v_fma_f32 v103, v103, s44, -v195
    v_fma_f32 v104, v104, s44, -v195
    v_fma_f32 v105, v105, s44, -v195
    v_fma_f32 v106, v106, s44, -v195
    v_fma_f32 v107, v107, s44, -v195
    v_fma_f32 v108, v108, s44, -v195
    v_fma_f32 v109, v109, s44, -v195
    v_fma_f32 v110, v110, s44, -v195
    v_fma_f32 v111, v111, s44, -v195
    v_exp_f32 v96, v96
    v_exp_f32 v97, v97
    v_exp_f32 v98, v98
    v_exp_f32 v99, v99
    v_exp_f32 v100, v100
    v_exp_f32 v101, v101
    v_exp_f32 v102, v102
    v_exp_f32 v103, v103
    v_exp_f32 v104, v104
    v_exp_f32 v105, v105
    v_exp_f32 v106, v106
    v_exp_f32 v107, v107
    v_exp_f32 v108, v108
    v_exp_f32 v109, v109
    v_exp_f32 v110, v110
    v_exp_f32 v111, v111
    v_mul_f32 v194, v194, v198
    v_add_f32 v194, v194, v96
    v_add_f32 v194, v194, v97
    v_add_f32 v194, v194, v98
    v_add_f32 v194, v194, v99
    v_add_f32 v194, v194, v100
    v_add_f32 v194, v194, v101
    v_add_f32 v194, v194, v102
    v_add_f32 v194, v194, v103
    v_add_f32 v194, v194, v104
    v_add_f32 v194, v194, v105
    v_add_f32 v194, v194, v106
    v_add_f32 v194, v194, v107
    v_add_f32 v194, v194, v108
    v_add_f32 v194, v194, v109
    v_add_f32 v194, v194, v110
    v_add_f32 v194, v194, v111
    v_cvt_pk_bf16_f32 v112, v96, v97
    v_cvt_pk_bf16_f32 v113, v98, v99
    v_cvt_pk_bf16_f32 v114, v100, v101
    v_cvt_pk_bf16_f32 v115, v102, v103
    v_cvt_pk_bf16_f32 v116, v104, v105
    v_cvt_pk_bf16_f32 v117, v106, v107
    v_cvt_pk_bf16_f32 v118, v108, v109
    v_cvt_pk_bf16_f32 v119, v110, v111
    v_mul_f32 v32, v32, v198
    v_mul_f32 v33, v33, v198
    v_mul_f32 v34, v34, v198
    v_mul_f32 v35, v35, v198
    v_mul_f32 v36, v36, v198
    v_mul_f32 v37, v37, v198
    v_mul_f32 v38, v38, v198
    v_mul_f32 v39, v39, v198
    v_mul_f32 v40, v40, v198
    v_mul_f32 v41, v41, v198
    v_mul_f32 v42, v42, v198
    v_mul_f32 v43, v43, v198
    v_mul_f32 v44, v44, v198
    v_mul_f32 v45, v45, v198
    v_mul_f32 v46, v46, v198
    v_mul_f32 v47, v47, v198
    v_mul_f32 v48, v48, v198
    v_mul_f32 v49, v49, v198
    v_mul_f32 v50, v50, v198
    v_mul_f32 v51, v51, v198
    v_mul_f32 v52, v52, v198
    v_mul_f32 v53, v53, v198
    v_mul_f32 v54, v54, v198
    v_mul_f32 v55, v55, v198
    v_mul_f32 v56, v56, v198
    v_mul_f32 v57, v57, v198
    v_mul_f32 v58, v58, v198
    v_mul_f32 v59, v59, v198
    v_mul_f32 v60, v60, v198
    v_mul_f32 v61, v61, v198
    v_mul_f32 v62, v62, v198
    v_mul_f32 v63, v63, v198
    v_mul_f32 v64, v64, v198
    v_mul_f32 v65, v65, v198
    v_mul_f32 v66, v66, v198
    v_mul_f32 v67, v67, v198
    v_mul_f32 v68, v68, v198
    v_mul_f32 v69, v69, v198
    v_mul_f32 v70, v70, v198
    v_mul_f32 v71, v71, v198
    v_mul_f32 v72, v72, v198
    v_mul_f32 v73, v73, v198
    v_mul_f32 v74, v74, v198
    v_mul_f32 v75, v75, v198
    v_mul_f32 v76, v76, v198
    v_mul_f32 v77, v77, v198
    v_mul_f32 v78, v78, v198
    v_mul_f32 v79, v79, v198
    v_mul_f32 v80, v80, v198
    v_mul_f32 v81, v81, v198
    v_mul_f32 v82, v82, v198
    v_mul_f32 v83, v83, v198
    v_mul_f32 v84, v84, v198
    v_mul_f32 v85, v85, v198
    v_mul_f32 v86, v86, v198
    v_mul_f32 v87, v87, v198
    v_mul_f32 v88, v88, v198
    v_mul_f32 v89, v89, v198
    v_mul_f32 v90, v90, v198
    v_mul_f32 v91, v91, v198
    v_mul_f32 v92, v92, v198
    v_mul_f32 v93, v93, v198
    v_mul_f32 v94, v94, v198
    v_mul_f32 v95, v95, v198
    s_waitcnt lgkmcnt(0)
    s_nop 1
    v_mfma_f32_32x32x16_bf16 v[32:47], v[120:123], v[112:115], v[32:47]
    v_mfma_f32_32x32x16_bf16 v[48:63], v[124:127], v[112:115], v[48:63]
    v_mfma_f32_32x32x16_bf16 v[64:79], v[128:131], v[112:115], v[64:79]
    v_mfma_f32_32x32x16_bf16 v[80:95], v[132:135], v[112:115], v[80:95]
    v_mfma_f32_32x32x16_bf16 v[32:47], v[136:139], v[116:119], v[32:47]
    v_mfma_f32_32x32x16_bf16 v[48:63], v[140:143], v[116:119], v[48:63]
    v_mfma_f32_32x32x16_bf16 v[64:79], v[144:147], v[116:119], v[64:79]
    v_mfma_f32_32x32x16_bf16 v[80:95], v[148:151], v[116:119], v[80:95]
    s_barrier
    ds_read_b128 v[120:123], v176 offset:32768
    ds_read_b128 v[124:127], v177 offset:32768
    ds_read_b128 v[128:131], v178 offset:32768
    ds_read_b128 v[132:135], v179 offset:32768
    ds_read_b128 v[136:139], v180 offset:32768
    ds_read_b128 v[140:143], v181 offset:32768
    ds_read_b128 v[144:147], v182 offset:32768
    ds_read_b128 v[148:151], v183 offset:32768
    s_waitcnt lgkmcnt(0)
    v_mfma_f32_32x32x16_bf16 v[96:111], v[120:123], v[0:3], 0
    v_mfma_f32_32x32x16_bf16 v[96:111], v[124:127], v[4:7], v[96:111]
    v_mfma_f32_32x32x16_bf16 v[96:111], v[128:131], v[8:11], v[96:111]
    v_mfma_f32_32x32x16_bf16 v[96:111], v[132:135], v[12:15], v[96:111]
    v_mfma_f32_32x32x16_bf16 v[96:111], v[136:139], v[16:19], v[96:111]
    v_mfma_f32_32x32x16_bf16 v[96:111], v[140:143], v[20:23], v[96:111]
    v_mfma_f32_32x32x16_bf16 v[96:111], v[144:147], v[24:27], v[96:111]
    v_mfma_f32_32x32x16_bf16 v[96:111], v[148:151], v[28:31], v[96:111]
    s_barrier
    ds_read_b64_tr_b16 v[120:121], v184 offset:40960
    ds_read_b64_tr_b16 v[122:123], v184 offset:43008
    ds_read_b64_tr_b16 v[124:125], v185 offset:40960
    ds_read_b64_tr_b16 v[126:127], v185 offset:43008
    ds_read_b64_tr_b16 v[128:129], v186 offset:40960
    ds_read_b64_tr_b16 v[130:131], v186 offset:43008
    ds_read_b64_tr_b16 v[132:133], v187 offset:40960
    ds_read_b64_tr_b16 v[134:135], v187 offset:43008
    ds_read_b64_tr_b16 v[136:137], v184 offset:45056
    ds_read_b64_tr_b16 v[138:139], v184 offset:47104
    ds_read_b64_tr_b16 v[140:141], v185 offset:45056
    ds_read_b64_tr_b16 v[142:143], v185 offset:47104
    ds_read_b64_tr_b16 v[144:145], v186 offset:45056
    ds_read_b64_tr_b16 v[146:147], v186 offset:47104
    ds_read_b64_tr_b16 v[148:149], v187 offset:45056
    ds_read_b64_tr_b16 v[150:151], v187 offset:47104
    s_nop 7
    v_max3_f32 v195, v96, v97, v98
    v_max3_f32 v195, v195, v99, v100
    v_max3_f32 v195, v195, v101, v102
    v_max3_f32 v195, v195, v103, v104
    v_max3_f32 v195, v195, v105, v106
    v_max3_f32 v195, v195, v107, v108
    v_max3_f32 v195, v195, v109, v110
    v_max_f32 v195, v195, v111
    v_mov_b32 v196, v195
    s_nop 1
    v_permlane32_swap_b32 v195, v196
    s_nop 1
    v_max3_f32 v195, v195, v196, v193
    v_sub_f32 v196, v193, v195
    v_mul_f32 v196, s44, v196
    v_exp_f32 v198, v196
    v_mov_b32 v193, v195
    v_mul_f32 v195, s44, v195
    v_fma_f32 v96, v96, s44, -v195
    v_fma_f32 v97, v97, s44, -v195
    v_fma_f32 v98, v98, s44, -v195
    v_fma_f32 v99, v99, s44, -v195
    v_fma_f32 v100, v100, s44, -v195
    v_fma_f32 v101, v101, s44, -v195
    v_fma_f32 v102, v102, s44, -v195
    v_fma_f32 v103, v103, s44, -v195
    v_fma_f32 v104, v104, s44, -v195
    v_fma_f32 v105, v105, s44, -v195
    v_fma_f32 v106, v106, s44, -v195
    v_fma_f32 v107, v107, s44, -v195
    v_fma_f32 v108, v108, s44, -v195
    v_fma_f32 v109, v109, s44, -v195
    v_fma_f32 v110, v110, s44, -v195
    v_fma_f32 v111, v111, s44, -v195
    v_exp_f32 v96, v96
    v_exp_f32 v97, v97
    v_exp_f32 v98, v98
    v_exp_f32 v99, v99
    v_exp_f32 v100, v100
    v_exp_f32 v101, v101
    v_exp_f32 v102, v102
    v_exp_f32 v103, v103
    v_exp_f32 v104, v104
    v_exp_f32 v105, v105
    v_exp_f32 v106, v106
    v_exp_f32 v107, v107
    v_exp_f32 v108, v108
    v_exp_f32 v109, v109
    v_exp_f32 v110, v110
    v_exp_f32 v111, v111
    v_mul_f32 v194, v194, v198
    v_add_f32 v194, v194, v96
    v_add_f32 v194, v194, v97
    v_add_f32 v194, v194, v98
    v_add_f32 v194, v194, v99
    v_add_f32 v194, v194, v100
    v_add_f32 v194, v194, v101
    v_add_f32 v194, v194, v102
    v_add_f32 v194, v194, v103
    v_add_f32 v194, v194, v104
    v_add_f32 v194, v194, v105
    v_add_f32 v194, v194, v106
    v_add_f32 v194, v194, v107
    v_add_f32 v194, v194, v108
    v_add_f32 v194, v194, v109
    v_add_f32 v194, v194, v110
    v_add_f32 v194, v194, v111
    v_cvt_pk_bf16_f32 v112, v96, v97
    v_cvt_pk_bf16_f32 v113, v98, v99
    v_cvt_pk_bf16_f32 v114, v100, v101
    v_cvt_pk_bf16_f32 v115, v102, v103
    v_cvt_pk_bf16_f32 v116, v104, v105
    v_cvt_pk_bf16_f32 v117, v106, v107
    v_cvt_pk_bf16_f32 v118, v108, v109
    v_cvt_pk_bf16_f32 v119, v110, v111
    v_mul_f32 v32, v32, v198
    v_mul_f32 v33, v33, v198
    v_mul_f32 v34, v34, v198
    v_mul_f32 v35, v35, v198
    v_mul_f32 v36, v36, v198
    v_mul_f32 v37, v37, v198
    v_mul_f32 v38, v38, v198
    v_mul_f32 v39, v39, v198
    v_mul_f32 v40, v40, v198
    v_mul_f32 v41, v41, v198
    v_mul_f32 v42, v42, v198
    v_mul_f32 v43, v43, v198
    v_mul_f32 v44, v44, v198
    v_mul_f32 v45, v45, v198
    v_mul_f32 v46, v46, v198
    v_mul_f32 v47, v47, v198
    v_mul_f32 v48, v48, v198
    v_mul_f32 v49, v49, v198
    v_mul_f32 v50, v50, v198
    v_mul_f32 v51, v51, v198
    v_mul_f32 v52, v52, v198
    v_mul_f32 v53, v53, v198
    v_mul_f32 v54, v54, v198
    v_mul_f32 v55, v55, v198
    v_mul_f32 v56, v56, v198
    v_mul_f32 v57, v57, v198
    v_mul_f32 v58, v58, v198
    v_mul_f32 v59, v59, v198
    v_mul_f32 v60, v60, v198
    v_mul_f32 v61, v61, v198
    v_mul_f32 v62, v62, v198
    v_mul_f32 v63, v63, v198
    v_mul_f32 v64, v64, v198
    v_mul_f32 v65, v65, v198
    v_mul_f32 v66, v66, v198
    v_mul_f32 v67, v67, v198
    v_mul_f32 v68, v68, v198
    v_mul_f32 v69, v69, v198
    v_mul_f32 v70, v70, v198
    v_mul_f32 v71, v71, v198
    v_mul_f32 v72, v72, v198
    v_mul_f32 v73, v73, v198
    v_mul_f32 v74, v74, v198
    v_mul_f32 v75, v75, v198
    v_mul_f32 v76, v76, v198
    v_mul_f32 v77, v77, v198
    v_mul_f32 v78, v78, v198
    v_mul_f32 v79, v79, v198
    v_mul_f32 v80, v80, v198
    v_mul_f32 v81, v81, v198
    v_mul_f32 v82, v82, v198
    v_mul_f32 v83, v83, v198
    v_mul_f32 v84, v84, v198
    v_mul_f32 v85, v85, v198
    v_mul_f32 v86, v86, v198
    v_mul_f32 v87, v87, v198
    v_mul_f32 v88, v88, v198
    v_mul_f32 v89, v89, v198
    v_mul_f32 v90, v90, v198
    v_mul_f32 v91, v91, v198
    v_mul_f32 v92, v92, v198
    v_mul_f32 v93, v93, v198
    v_mul_f32 v94, v94, v198
    v_mul_f32 v95, v95, v198
    s_waitcnt lgkmcnt(0)
    s_nop 1
    v_mfma_f32_32x32x16_bf16 v[32:47], v[120:123], v[112:115], v[32:47]
    v_mfma_f32_32x32x16_bf16 v[48:63], v[124:127], v[112:115], v[48:63]
    v_mfma_f32_32x32x16_bf16 v[64:79], v[128:131], v[112:115], v[64:79]
    v_mfma_f32_32x32x16_bf16 v[80:95], v[132:135], v[112:115], v[80:95]
    v_mfma_f32_32x32x16_bf16 v[32:47], v[136:139], v[116:119], v[32:47]
    v_mfma_f32_32x32x16_bf16 v[48:63], v[140:143], v[116:119], v[48:63]
    v_mfma_f32_32x32x16_bf16 v[64:79], v[144:147], v[116:119], v[64:79]
    v_mfma_f32_32x32x16_bf16 v[80:95], v[148:151], v[116:119], v[80:95]
    s_barrier
    ds_read_b128 v[120:123], v176 offset:49152
    ds_read_b128 v[124:127], v177 offset:49152
    ds_read_b128 v[128:131], v178 offset:49152
    ds_read_b128 v[132:135], v179 offset:49152
    ds_read_b128 v[136:139], v180 offset:49152
    ds_read_b128 v[140:143], v181 offset:49152
    ds_read_b128 v[144:147], v182 offset:49152
    ds_read_b128 v[148:151], v183 offset:49152
    s_waitcnt lgkmcnt(0)
    v_mfma_f32_32x32x16_bf16 v[96:111], v[120:123], v[0:3], 0
    v_mfma_f32_32x32x16_bf16 v[96:111], v[124:127], v[4:7], v[96:111]
    v_mfma_f32_32x32x16_bf16 v[96:111], v[128:131], v[8:11], v[96:111]
    v_mfma_f32_32x32x16_bf16 v[96:111], v[132:135], v[12:15], v[96:111]
    v_mfma_f32_32x32x16_bf16 v[96:111], v[136:139], v[16:19], v[96:111]
    v_mfma_f32_32x32x16_bf16 v[96:111], v[140:143], v[20:23], v[96:111]
    v_mfma_f32_32x32x16_bf16 v[96:111], v[144:147], v[24:27], v[96:111]
    v_mfma_f32_32x32x16_bf16 v[96:111], v[148:151], v[28:31], v[96:111]
    s_barrier
    ds_read_b64_tr_b16 v[120:121], v184 offset:57344
    ds_read_b64_tr_b16 v[122:123], v184 offset:59392
    ds_read_b64_tr_b16 v[124:125], v185 offset:57344
    ds_read_b64_tr_b16 v[126:127], v185 offset:59392
    ds_read_b64_tr_b16 v[128:129], v186 offset:57344
    ds_read_b64_tr_b16 v[130:131], v186 offset:59392
    ds_read_b64_tr_b16 v[132:133], v187 offset:57344
    ds_read_b64_tr_b16 v[134:135], v187 offset:59392
    ds_read_b64_tr_b16 v[136:137], v184 offset:61440
    ds_read_b64_tr_b16 v[138:139], v184 offset:63488
    ds_read_b64_tr_b16 v[140:141], v185 offset:61440
    ds_read_b64_tr_b16 v[142:143], v185 offset:63488
    ds_read_b64_tr_b16 v[144:145], v186 offset:61440
    ds_read_b64_tr_b16 v[146:147], v186 offset:63488
    ds_read_b64_tr_b16 v[148:149], v187 offset:61440
    ds_read_b64_tr_b16 v[150:151], v187 offset:63488
    s_nop 7
    v_max3_f32 v195, v96, v97, v98
    v_max3_f32 v195, v195, v99, v100
    v_max3_f32 v195, v195, v101, v102
    v_max3_f32 v195, v195, v103, v104
    v_max3_f32 v195, v195, v105, v106
    v_max3_f32 v195, v195, v107, v108
    v_max3_f32 v195, v195, v109, v110
    v_max_f32 v195, v195, v111
    v_mov_b32 v196, v195
    s_nop 1
    v_permlane32_swap_b32 v195, v196
    s_nop 1
    v_max3_f32 v195, v195, v196, v193
    v_sub_f32 v196, v193, v195
    v_mul_f32 v196, s44, v196
    v_exp_f32 v198, v196
    v_mov_b32 v193, v195
    v_mul_f32 v195, s44, v195
    v_fma_f32 v96, v96, s44, -v195
    v_fma_f32 v97, v97, s44, -v195
    v_fma_f32 v98, v98, s44, -v195
    v_fma_f32 v99, v99, s44, -v195
    v_fma_f32 v100, v100, s44, -v195
    v_fma_f32 v101, v101, s44, -v195
    v_fma_f32 v102, v102, s44, -v195
    v_fma_f32 v103, v103, s44, -v195
    v_fma_f32 v104, v104, s44, -v195
    v_fma_f32 v105, v105, s44, -v195
    v_fma_f32 v106, v106, s44, -v195
    v_fma_f32 v107, v107, s44, -v195
    v_fma_f32 v108, v108, s44, -v195
    v_fma_f32 v109, v109, s44, -v195
    v_fma_f32 v110, v110, s44, -v195
    v_fma_f32 v111, v111, s44, -v195
    v_exp_f32 v96, v96
    v_exp_f32 v97, v97
    v_exp_f32 v98, v98
    v_exp_f32 v99, v99
    v_exp_f32 v100, v100
    v_exp_f32 v101, v101
    v_exp_f32 v102, v102
    v_exp_f32 v103, v103
    v_exp_f32 v104, v104
    v_exp_f32 v105, v105
    v_exp_f32 v106, v106
    v_exp_f32 v107, v107
    v_exp_f32 v108, v108
    v_exp_f32 v109, v109
    v_exp_f32 v110, v110
    v_exp_f32 v111, v111
    v_mul_f32 v194, v194, v198
    v_add_f32 v194, v194, v96
    v_add_f32 v194, v194, v97
    v_add_f32 v194, v194, v98
    v_add_f32 v194, v194, v99
    v_add_f32 v194, v194, v100
    v_add_f32 v194, v194, v101
    v_add_f32 v194, v194, v102
    v_add_f32 v194, v194, v103
    v_add_f32 v194, v194, v104
    v_add_f32 v194, v194, v105
    v_add_f32 v194, v194, v106
    v_add_f32 v194, v194, v107
    v_add_f32 v194, v194, v108
    v_add_f32 v194, v194, v109
    v_add_f32 v194, v194, v110
    v_add_f32 v194, v194, v111
    v_cvt_pk_bf16_f32 v112, v96, v97
    v_cvt_pk_bf16_f32 v113, v98, v99
    v_cvt_pk_bf16_f32 v114, v100, v101
    v_cvt_pk_bf16_f32 v115, v102, v103
    v_cvt_pk_bf16_f32 v116, v104, v105
    v_cvt_pk_bf16_f32 v117, v106, v107
    v_cvt_pk_bf16_f32 v118, v108, v109
    v_cvt_pk_bf16_f32 v119, v110, v111
    v_mul_f32 v32, v32, v198
    v_mul_f32 v33, v33, v198
    v_mul_f32 v34, v34, v198
    v_mul_f32 v35, v35, v198
    v_mul_f32 v36, v36, v198
    v_mul_f32 v37, v37, v198
    v_mul_f32 v38, v38, v198
    v_mul_f32 v39, v39, v198
    v_mul_f32 v40, v40, v198
    v_mul_f32 v41, v41, v198
    v_mul_f32 v42, v42, v198
    v_mul_f32 v43, v43, v198
    v_mul_f32 v44, v44, v198
    v_mul_f32 v45, v45, v198
    v_mul_f32 v46, v46, v198
    v_mul_f32 v47, v47, v198
    v_mul_f32 v48, v48, v198
    v_mul_f32 v49, v49, v198
    v_mul_f32 v50, v50, v198
    v_mul_f32 v51, v51, v198
    v_mul_f32 v52, v52, v198
    v_mul_f32 v53, v53, v198
    v_mul_f32 v54, v54, v198
    v_mul_f32 v55, v55, v198
    v_mul_f32 v56, v56, v198
    v_mul_f32 v57, v57, v198
    v_mul_f32 v58, v58, v198
    v_mul_f32 v59, v59, v198
    v_mul_f32 v60, v60, v198
    v_mul_f32 v61, v61, v198
    v_mul_f32 v62, v62, v198
    v_mul_f32 v63, v63, v198
    v_mul_f32 v64, v64, v198
    v_mul_f32 v65, v65, v198
    v_mul_f32 v66, v66, v198
    v_mul_f32 v67, v67, v198
    v_mul_f32 v68, v68, v198
    v_mul_f32 v69, v69, v198
    v_mul_f32 v70, v70, v198
    v_mul_f32 v71, v71, v198
    v_mul_f32 v72, v72, v198
    v_mul_f32 v73, v73, v198
    v_mul_f32 v74, v74, v198
    v_mul_f32 v75, v75, v198
    v_mul_f32 v76, v76, v198
    v_mul_f32 v77, v77, v198
    v_mul_f32 v78, v78, v198
    v_mul_f32 v79, v79, v198
    v_mul_f32 v80, v80, v198
    v_mul_f32 v81, v81, v198
    v_mul_f32 v82, v82, v198
    v_mul_f32 v83, v83, v198
    v_mul_f32 v84, v84, v198
    v_mul_f32 v85, v85, v198
    v_mul_f32 v86, v86, v198
    v_mul_f32 v87, v87, v198
    v_mul_f32 v88, v88, v198
    v_mul_f32 v89, v89, v198
    v_mul_f32 v90, v90, v198
    v_mul_f32 v91, v91, v198
    v_mul_f32 v92, v92, v198
    v_mul_f32 v93, v93, v198
    v_mul_f32 v94, v94, v198
    v_mul_f32 v95, v95, v198
    s_waitcnt lgkmcnt(0)
    s_nop 1
    v_mfma_f32_32x32x16_bf16 v[32:47], v[120:123], v[112:115], v[32:47]
    v_mfma_f32_32x32x16_bf16 v[48:63], v[124:127], v[112:115], v[48:63]
    v_mfma_f32_32x32x16_bf16 v[64:79], v[128:131], v[112:115], v[64:79]
    v_mfma_f32_32x32x16_bf16 v[80:95], v[132:135], v[112:115], v[80:95]
    v_mfma_f32_32x32x16_bf16 v[32:47], v[136:139], v[116:119], v[32:47]
    v_mfma_f32_32x32x16_bf16 v[48:63], v[140:143], v[116:119], v[48:63]
    v_mfma_f32_32x32x16_bf16 v[64:79], v[144:147], v[116:119], v[64:79]
    v_mfma_f32_32x32x16_bf16 v[80:95], v[148:151], v[116:119], v[80:95]
    s_barrier
    ds_read_b128 v[120:123], v176 offset:0
    ds_read_b128 v[124:127], v177 offset:0
    ds_read_b128 v[128:131], v178 offset:0
    ds_read_b128 v[132:135], v179 offset:0
    ds_read_b128 v[136:139], v180 offset:0
    ds_read_b128 v[140:143], v181 offset:0
    ds_read_b128 v[144:147], v182 offset:0
    ds_read_b128 v[148:151], v183 offset:0
    s_waitcnt lgkmcnt(0)
    v_mfma_f32_32x32x16_bf16 v[96:111], v[120:123], v[0:3], 0
    v_mfma_f32_32x32x16_bf16 v[96:111], v[124:127], v[4:7], v[96:111]
    v_mfma_f32_32x32x16_bf16 v[96:111], v[128:131], v[8:11], v[96:111]
    v_mfma_f32_32x32x16_bf16 v[96:111], v[132:135], v[12:15], v[96:111]
    v_mfma_f32_32x32x16_bf16 v[96:111], v[136:139], v[16:19], v[96:111]
    v_mfma_f32_32x32x16_bf16 v[96:111], v[140:143], v[20:23], v[96:111]
    v_mfma_f32_32x32x16_bf16 v[96:111], v[144:147], v[24:27], v[96:111]
    v_mfma_f32_32x32x16_bf16 v[96:111], v[148:151], v[28:31], v[96:111]
    s_barrier
    ds_read_b64_tr_b16 v[120:121], v184 offset:8192
    ds_read_b64_tr_b16 v[122:123], v184 offset:10240
    ds_read_b64_tr_b16 v[124:125], v185 offset:8192
    ds_read_b64_tr_b16 v[126:127], v185 offset:10240
    ds_read_b64_tr_b16 v[128:129], v186 offset:8192
    ds_read_b64_tr_b16 v[130:131], v186 offset:10240
    ds_read_b64_tr_b16 v[132:133], v187 offset:8192
    ds_read_b64_tr_b16 v[134:135], v187 offset:10240
    ds_read_b64_tr_b16 v[136:137], v184 offset:12288
    ds_read_b64_tr_b16 v[138:139], v184 offset:14336
    ds_read_b64_tr_b16 v[140:141], v185 offset:12288
    ds_read_b64_tr_b16 v[142:143], v185 offset:14336
    ds_read_b64_tr_b16 v[144:145], v186 offset:12288
    ds_read_b64_tr_b16 v[146:147], v186 offset:14336
    ds_read_b64_tr_b16 v[148:149], v187 offset:12288
    ds_read_b64_tr_b16 v[150:151], v187 offset:14336
    s_nop 7
    v_max3_f32 v195, v96, v97, v98
    v_max3_f32 v195, v195, v99, v100
    v_max3_f32 v195, v195, v101, v102
    v_max3_f32 v195, v195, v103, v104
    v_max3_f32 v195, v195, v105, v106
    v_max3_f32 v195, v195, v107, v108
    v_max3_f32 v195, v195, v109, v110
    v_max_f32 v195, v195, v111
    v_mov_b32 v196, v195
    s_nop 1
    v_permlane32_swap_b32 v195, v196
    s_nop 1
    v_max3_f32 v195, v195, v196, v193
    v_sub_f32 v196, v193, v195
    v_mul_f32 v196, s44, v196
    v_exp_f32 v198, v196
    v_mov_b32 v193, v195
    v_mul_f32 v195, s44, v195
    v_fma_f32 v96, v96, s44, -v195
    v_fma_f32 v97, v97, s44, -v195
    v_fma_f32 v98, v98, s44, -v195
    v_fma_f32 v99, v99, s44, -v195
    v_fma_f32 v100, v100, s44, -v195
    v_fma_f32 v101, v101, s44, -v195
    v_fma_f32 v102, v102, s44, -v195
    v_fma_f32 v103, v103, s44, -v195
    v_fma_f32 v104, v104, s44, -v195
    v_fma_f32 v105, v105, s44, -v195
    v_fma_f32 v106, v106, s44, -v195
    v_fma_f32 v107, v107, s44, -v195
    v_fma_f32 v108, v108, s44, -v195
    v_fma_f32 v109, v109, s44, -v195
    v_fma_f32 v110, v110, s44, -v195
    v_fma_f32 v111, v111, s44, -v195
    v_exp_f32 v96, v96
    v_exp_f32 v97, v97
    v_exp_f32 v98, v98
    v_exp_f32 v99, v99
    v_exp_f32 v100, v100
    v_exp_f32 v101, v101
    v_exp_f32 v102, v102
    v_exp_f32 v103, v103
    v_exp_f32 v104, v104
    v_exp_f32 v105, v105
    v_exp_f32 v106, v106
    v_exp_f32 v107, v107
    v_exp_f32 v108, v108
    v_exp_f32 v109, v109
    v_exp_f32 v110, v110
    v_exp_f32 v111, v111
    v_mul_f32 v194, v194, v198
    v_add_f32 v194, v194, v96
    v_add_f32 v194, v194, v97
    v_add_f32 v194, v194, v98
    v_add_f32 v194, v194, v99
    v_add_f32 v194, v194, v100
    v_add_f32 v194, v194, v101
    v_add_f32 v194, v194, v102
    v_add_f32 v194, v194, v103
    v_add_f32 v194, v194, v104
    v_add_f32 v194, v194, v105
    v_add_f32 v194, v194, v106
    v_add_f32 v194, v194, v107
    v_add_f32 v194, v194, v108
    v_add_f32 v194, v194, v109
    v_add_f32 v194, v194, v110
    v_add_f32 v194, v194, v111
    v_cvt_pk_bf16_f32 v112, v96, v97
    v_cvt_pk_bf16_f32 v113, v98, v99
    v_cvt_pk_bf16_f32 v114, v100, v101
    v_cvt_pk_bf16_f32 v115, v102, v103
    v_cvt_pk_bf16_f32 v116, v104, v105
    v_cvt_pk_bf16_f32 v117, v106, v107
    v_cvt_pk_bf16_f32 v118, v108, v109
    v_cvt_pk_bf16_f32 v119, v110, v111
    v_mul_f32 v32, v32, v198
    v_mul_f32 v33, v33, v198
    v_mul_f32 v34, v34, v198
    v_mul_f32 v35, v35, v198
    v_mul_f32 v36, v36, v198
    v_mul_f32 v37, v37, v198
    v_mul_f32 v38, v38, v198
    v_mul_f32 v39, v39, v198
    v_mul_f32 v40, v40, v198
    v_mul_f32 v41, v41, v198
    v_mul_f32 v42, v42, v198
    v_mul_f32 v43, v43, v198
    v_mul_f32 v44, v44, v198
    v_mul_f32 v45, v45, v198
    v_mul_f32 v46, v46, v198
    v_mul_f32 v47, v47, v198
    v_mul_f32 v48, v48, v198
    v_mul_f32 v49, v49, v198
    v_mul_f32 v50, v50, v198
    v_mul_f32 v51, v51, v198
    v_mul_f32 v52, v52, v198
    v_mul_f32 v53, v53, v198
    v_mul_f32 v54, v54, v198
    v_mul_f32 v55, v55, v198
    v_mul_f32 v56, v56, v198
    v_mul_f32 v57, v57, v198
    v_mul_f32 v58, v58, v198
    v_mul_f32 v59, v59, v198
    v_mul_f32 v60, v60, v198
    v_mul_f32 v61, v61, v198
    v_mul_f32 v62, v62, v198
    v_mul_f32 v63, v63, v198
    v_mul_f32 v64, v64, v198
    v_mul_f32 v65, v65, v198
    v_mul_f32 v66, v66, v198
    v_mul_f32 v67, v67, v198
    v_mul_f32 v68, v68, v198
    v_mul_f32 v69, v69, v198
    v_mul_f32 v70, v70, v198
    v_mul_f32 v71, v71, v198
    v_mul_f32 v72, v72, v198
    v_mul_f32 v73, v73, v198
    v_mul_f32 v74, v74, v198
    v_mul_f32 v75, v75, v198
    v_mul_f32 v76, v76, v198
    v_mul_f32 v77, v77, v198
    v_mul_f32 v78, v78, v198
    v_mul_f32 v79, v79, v198
    v_mul_f32 v80, v80, v198
    v_mul_f32 v81, v81, v198
    v_mul_f32 v82, v82, v198
    v_mul_f32 v83, v83, v198
    v_mul_f32 v84, v84, v198
    v_mul_f32 v85, v85, v198
    v_mul_f32 v86, v86, v198
    v_mul_f32 v87, v87, v198
    v_mul_f32 v88, v88, v198
    v_mul_f32 v89, v89, v198
    v_mul_f32 v90, v90, v198
    v_mul_f32 v91, v91, v198
    v_mul_f32 v92, v92, v198
    v_mul_f32 v93, v93, v198
    v_mul_f32 v94, v94, v198
    v_mul_f32 v95, v95, v198
    s_waitcnt lgkmcnt(0)
    s_nop 1
    v_mfma_f32_32x32x16_bf16 v[32:47], v[120:123], v[112:115], v[32:47]
    v_mfma_f32_32x32x16_bf16 v[48:63], v[124:127], v[112:115], v[48:63]
    v_mfma_f32_32x32x16_bf16 v[64:79], v[128:131], v[112:115], v[64:79]
    v_mfma_f32_32x32x16_bf16 v[80:95], v[132:135], v[112:115], v[80:95]
    v_mfma_f32_32x32x16_bf16 v[32:47], v[136:139], v[116:119], v[32:47]
    v_mfma_f32_32x32x16_bf16 v[48:63], v[140:143], v[116:119], v[48:63]
    v_mfma_f32_32x32x16_bf16 v[64:79], v[144:147], v[116:119], v[64:79]
    v_mfma_f32_32x32x16_bf16 v[80:95], v[148:151], v[116:119], v[80:95]
    s_barrier
    ds_read_b128 v[120:123], v176 offset:16384
    ds_read_b128 v[124:127], v177 offset:16384
    ds_read_b128 v[128:131], v178 offset:16384
    ds_read_b128 v[132:135], v179 offset:16384
    ds_read_b128 v[136:139], v180 offset:16384
    ds_read_b128 v[140:143], v181 offset:16384
    ds_read_b128 v[144:147], v182 offset:16384
    ds_read_b128 v[148:151], v183 offset:16384
    s_waitcnt lgkmcnt(0)
    v_mfma_f32_32x32x16_bf16 v[96:111], v[120:123], v[0:3], 0
    v_mfma_f32_32x32x16_bf16 v[96:111], v[124:127], v[4:7], v[96:111]
    v_mfma_f32_32x32x16_bf16 v[96:111], v[128:131], v[8:11], v[96:111]
    v_mfma_f32_32x32x16_bf16 v[96:111], v[132:135], v[12:15], v[96:111]
    v_mfma_f32_32x32x16_bf16 v[96:111], v[136:139], v[16:19], v[96:111]
    v_mfma_f32_32x32x16_bf16 v[96:111], v[140:143], v[20:23], v[96:111]
    v_mfma_f32_32x32x16_bf16 v[96:111], v[144:147], v[24:27], v[96:111]
    v_mfma_f32_32x32x16_bf16 v[96:111], v[148:151], v[28:31], v[96:111]
    s_barrier
    ds_read_b64_tr_b16 v[120:121], v184 offset:24576
    ds_read_b64_tr_b16 v[122:123], v184 offset:26624
    ds_read_b64_tr_b16 v[124:125], v185 offset:24576
    ds_read_b64_tr_b16 v[126:127], v185 offset:26624
    ds_read_b64_tr_b16 v[128:129], v186 offset:24576
    ds_read_b64_tr_b16 v[130:131], v186 offset:26624
    ds_read_b64_tr_b16 v[132:133], v187 offset:24576
    ds_read_b64_tr_b16 v[134:135], v187 offset:26624
    ds_read_b64_tr_b16 v[136:137], v184 offset:28672
    ds_read_b64_tr_b16 v[138:139], v184 offset:30720
    ds_read_b64_tr_b16 v[140:141], v185 offset:28672
    ds_read_b64_tr_b16 v[142:143], v185 offset:30720
    ds_read_b64_tr_b16 v[144:145], v186 offset:28672
    ds_read_b64_tr_b16 v[146:147], v186 offset:30720
    ds_read_b64_tr_b16 v[148:149], v187 offset:28672
    ds_read_b64_tr_b16 v[150:151], v187 offset:30720
    s_nop 7
    v_max3_f32 v195, v96, v97, v98
    v_max3_f32 v195, v195, v99, v100
    v_max3_f32 v195, v195, v101, v102
    v_max3_f32 v195, v195, v103, v104
    v_max3_f32 v195, v195, v105, v106
    v_max3_f32 v195, v195, v107, v108
    v_max3_f32 v195, v195, v109, v110
    v_max_f32 v195, v195, v111
    v_mov_b32 v196, v195
    s_nop 1
    v_permlane32_swap_b32 v195, v196
    s_nop 1
    v_max3_f32 v195, v195, v196, v193
    v_sub_f32 v196, v193, v195
    v_mul_f32 v196, s44, v196
    v_exp_f32 v198, v196
    v_mov_b32 v193, v195
    v_mul_f32 v195, s44, v195
    v_fma_f32 v96, v96, s44, -v195
    v_fma_f32 v97, v97, s44, -v195
    v_fma_f32 v98, v98, s44, -v195
    v_fma_f32 v99, v99, s44, -v195
    v_fma_f32 v100, v100, s44, -v195
    v_fma_f32 v101, v101, s44, -v195
    v_fma_f32 v102, v102, s44, -v195
    v_fma_f32 v103, v103, s44, -v195
    v_fma_f32 v104, v104, s44, -v195
    v_fma_f32 v105, v105, s44, -v195
    v_fma_f32 v106, v106, s44, -v195
    v_fma_f32 v107, v107, s44, -v195
    v_fma_f32 v108, v108, s44, -v195
    v_fma_f32 v109, v109, s44, -v195
    v_fma_f32 v110, v110, s44, -v195
    v_fma_f32 v111, v111, s44, -v195
    v_exp_f32 v96, v96
    v_exp_f32 v97, v97
    v_exp_f32 v98, v98
    v_exp_f32 v99, v99
    v_exp_f32 v100, v100
    v_exp_f32 v101, v101
    v_exp_f32 v102, v102
    v_exp_f32 v103, v103
    v_exp_f32 v104, v104
    v_exp_f32 v105, v105
    v_exp_f32 v106, v106
    v_exp_f32 v107, v107
    v_exp_f32 v108, v108
    v_exp_f32 v109, v109
    v_exp_f32 v110, v110
    v_exp_f32 v111, v111
    v_mul_f32 v194, v194, v198
    v_add_f32 v194, v194, v96
    v_add_f32 v194, v194, v97
    v_add_f32 v194, v194, v98
    v_add_f32 v194, v194, v99
    v_add_f32 v194, v194, v100
    v_add_f32 v194, v194, v101
    v_add_f32 v194, v194, v102
    v_add_f32 v194, v194, v103
    v_add_f32 v194, v194, v104
    v_add_f32 v194, v194, v105
    v_add_f32 v194, v194, v106
    v_add_f32 v194, v194, v107
    v_add_f32 v194, v194, v108
    v_add_f32 v194, v194, v109
    v_add_f32 v194, v194, v110
    v_add_f32 v194, v194, v111
    v_cvt_pk_bf16_f32 v112, v96, v97
    v_cvt_pk_bf16_f32 v113, v98, v99
    v_cvt_pk_bf16_f32 v114, v100, v101
    v_cvt_pk_bf16_f32 v115, v102, v103
    v_cvt_pk_bf16_f32 v116, v104, v105
    v_cvt_pk_bf16_f32 v117, v106, v107
    v_cvt_pk_bf16_f32 v118, v108, v109
    v_cvt_pk_bf16_f32 v119, v110, v111
    v_mul_f32 v32, v32, v198
    v_mul_f32 v33, v33, v198
    v_mul_f32 v34, v34, v198
    v_mul_f32 v35, v35, v198
    v_mul_f32 v36, v36, v198
    v_mul_f32 v37, v37, v198
    v_mul_f32 v38, v38, v198
    v_mul_f32 v39, v39, v198
    v_mul_f32 v40, v40, v198
    v_mul_f32 v41, v41, v198
    v_mul_f32 v42, v42, v198
    v_mul_f32 v43, v43, v198
    v_mul_f32 v44, v44, v198
    v_mul_f32 v45, v45, v198
    v_mul_f32 v46, v46, v198
    v_mul_f32 v47, v47, v198
    v_mul_f32 v48, v48, v198
    v_mul_f32 v49, v49, v198
    v_mul_f32 v50, v50, v198
    v_mul_f32 v51, v51, v198
    v_mul_f32 v52, v52, v198
    v_mul_f32 v53, v53, v198
    v_mul_f32 v54, v54, v198
    v_mul_f32 v55, v55, v198
    v_mul_f32 v56, v56, v198
    v_mul_f32 v57, v57, v198
    v_mul_f32 v58, v58, v198
    v_mul_f32 v59, v59, v198
    v_mul_f32 v60, v60, v198
    v_mul_f32 v61, v61, v198
    v_mul_f32 v62, v62, v198
    v_mul_f32 v63, v63, v198
    v_mul_f32 v64, v64, v198
    v_mul_f32 v65, v65, v198
    v_mul_f32 v66, v66, v198
    v_mul_f32 v67, v67, v198
    v_mul_f32 v68, v68, v198
    v_mul_f32 v69, v69, v198
    v_mul_f32 v70, v70, v198
    v_mul_f32 v71, v71, v198
    v_mul_f32 v72, v72, v198
    v_mul_f32 v73, v73, v198
    v_mul_f32 v74, v74, v198
    v_mul_f32 v75, v75, v198
    v_mul_f32 v76, v76, v198
    v_mul_f32 v77, v77, v198
    v_mul_f32 v78, v78, v198
    v_mul_f32 v79, v79, v198
    v_mul_f32 v80, v80, v198
    v_mul_f32 v81, v81, v198
    v_mul_f32 v82, v82, v198
    v_mul_f32 v83, v83, v198
    v_mul_f32 v84, v84, v198
    v_mul_f32 v85, v85, v198
    v_mul_f32 v86, v86, v198
    v_mul_f32 v87, v87, v198
    v_mul_f32 v88, v88, v198
    v_mul_f32 v89, v89, v198
    v_mul_f32 v90, v90, v198
    v_mul_f32 v91, v91, v198
    v_mul_f32 v92, v92, v198
    v_mul_f32 v93, v93, v198
    v_mul_f32 v94, v94, v198
    v_mul_f32 v95, v95, v198
    s_waitcnt lgkmcnt(0)
    s_nop 1
    v_mfma_f32_32x32x16_bf16 v[32:47], v[120:123], v[112:115], v[32:47]
    v_mfma_f32_32x32x16_bf16 v[48:63], v[124:127], v[112:115], v[48:63]
    v_mfma_f32_32x32x16_bf16 v[64:79], v[128:131], v[112:115], v[64:79]
    v_mfma_f32_32x32x16_bf16 v[80:95], v[132:135], v[112:115], v[80:95]
    v_mfma_f32_32x32x16_bf16 v[32:47], v[136:139], v[116:119], v[32:47]
    v_mfma_f32_32x32x16_bf16 v[48:63], v[140:143], v[116:119], v[48:63]
    v_mfma_f32_32x32x16_bf16 v[64:79], v[144:147], v[116:119], v[64:79]
    v_mfma_f32_32x32x16_bf16 v[80:95], v[148:151], v[116:119], v[80:95]
    s_barrier
    ds_read_b128 v[120:123], v176 offset:32768
    ds_read_b128 v[124:127], v177 offset:32768
    ds_read_b128 v[128:131], v178 offset:32768
    ds_read_b128 v[132:135], v179 offset:32768
    ds_read_b128 v[136:139], v180 offset:32768
    ds_read_b128 v[140:143], v181 offset:32768
    ds_read_b128 v[144:147], v182 offset:32768
    ds_read_b128 v[148:151], v183 offset:32768
    s_waitcnt lgkmcnt(0)
    v_mfma_f32_32x32x16_bf16 v[96:111], v[120:123], v[0:3], 0
    v_mfma_f32_32x32x16_bf16 v[96:111], v[124:127], v[4:7], v[96:111]
    v_mfma_f32_32x32x16_bf16 v[96:111], v[128:131], v[8:11], v[96:111]
    v_mfma_f32_32x32x16_bf16 v[96:111], v[132:135], v[12:15], v[96:111]
    v_mfma_f32_32x32x16_bf16 v[96:111], v[136:139], v[16:19], v[96:111]
    v_mfma_f32_32x32x16_bf16 v[96:111], v[140:143], v[20:23], v[96:111]
    v_mfma_f32_32x32x16_bf16 v[96:111], v[144:147], v[24:27], v[96:111]
    v_mfma_f32_32x32x16_bf16 v[96:111], v[148:151], v[28:31], v[96:111]
    s_barrier
    ds_read_b64_tr_b16 v[120:121], v184 offset:40960
    ds_read_b64_tr_b16 v[122:123], v184 offset:43008
    ds_read_b64_tr_b16 v[124:125], v185 offset:40960
    ds_read_b64_tr_b16 v[126:127], v185 offset:43008
    ds_read_b64_tr_b16 v[128:129], v186 offset:40960
    ds_read_b64_tr_b16 v[130:131], v186 offset:43008
    ds_read_b64_tr_b16 v[132:133], v187 offset:40960
    ds_read_b64_tr_b16 v[134:135], v187 offset:43008
    ds_read_b64_tr_b16 v[136:137], v184 offset:45056
    ds_read_b64_tr_b16 v[138:139], v184 offset:47104
    ds_read_b64_tr_b16 v[140:141], v185 offset:45056
    ds_read_b64_tr_b16 v[142:143], v185 offset:47104
    ds_read_b64_tr_b16 v[144:145], v186 offset:45056
    ds_read_b64_tr_b16 v[146:147], v186 offset:47104
    ds_read_b64_tr_b16 v[148:149], v187 offset:45056
    ds_read_b64_tr_b16 v[150:151], v187 offset:47104
    s_nop 7
    v_max3_f32 v195, v96, v97, v98
    v_max3_f32 v195, v195, v99, v100
    v_max3_f32 v195, v195, v101, v102
    v_max3_f32 v195, v195, v103, v104
    v_max3_f32 v195, v195, v105, v106
    v_max3_f32 v195, v195, v107, v108
    v_max3_f32 v195, v195, v109, v110
    v_max_f32 v195, v195, v111
    v_mov_b32 v196, v195
    s_nop 1
    v_permlane32_swap_b32 v195, v196
    s_nop 1
    v_max3_f32 v195, v195, v196, v193
    v_sub_f32 v196, v193, v195
    v_mul_f32 v196, s44, v196
    v_exp_f32 v198, v196
    v_mov_b32 v193, v195
    v_mul_f32 v195, s44, v195
    v_fma_f32 v96, v96, s44, -v195
    v_fma_f32 v97, v97, s44, -v195
    v_fma_f32 v98, v98, s44, -v195
    v_fma_f32 v99, v99, s44, -v195
    v_fma_f32 v100, v100, s44, -v195
    v_fma_f32 v101, v101, s44, -v195
    v_fma_f32 v102, v102, s44, -v195
    v_fma_f32 v103, v103, s44, -v195
    v_fma_f32 v104, v104, s44, -v195
    v_fma_f32 v105, v105, s44, -v195
    v_fma_f32 v106, v106, s44, -v195
    v_fma_f32 v107, v107, s44, -v195
    v_fma_f32 v108, v108, s44, -v195
    v_fma_f32 v109, v109, s44, -v195
    v_fma_f32 v110, v110, s44, -v195
    v_fma_f32 v111, v111, s44, -v195
    v_exp_f32 v96, v96
    v_exp_f32 v97, v97
    v_exp_f32 v98, v98
    v_exp_f32 v99, v99
    v_exp_f32 v100, v100
    v_exp_f32 v101, v101
    v_exp_f32 v102, v102
    v_exp_f32 v103, v103
    v_exp_f32 v104, v104
    v_exp_f32 v105, v105
    v_exp_f32 v106, v106
    v_exp_f32 v107, v107
    v_exp_f32 v108, v108
    v_exp_f32 v109, v109
    v_exp_f32 v110, v110
    v_exp_f32 v111, v111
    v_mul_f32 v194, v194, v198
    v_add_f32 v194, v194, v96
    v_add_f32 v194, v194, v97
    v_add_f32 v194, v194, v98
    v_add_f32 v194, v194, v99
    v_add_f32 v194, v194, v100
    v_add_f32 v194, v194, v101
    v_add_f32 v194, v194, v102
    v_add_f32 v194, v194, v103
    v_add_f32 v194, v194, v104
    v_add_f32 v194, v194, v105
    v_add_f32 v194, v194, v106
    v_add_f32 v194, v194, v107
    v_add_f32 v194, v194, v108
    v_add_f32 v194, v194, v109
    v_add_f32 v194, v194, v110
    v_add_f32 v194, v194, v111
    v_cvt_pk_bf16_f32 v112, v96, v97
    v_cvt_pk_bf16_f32 v113, v98, v99
    v_cvt_pk_bf16_f32 v114, v100, v101
    v_cvt_pk_bf16_f32 v115, v102, v103
    v_cvt_pk_bf16_f32 v116, v104, v105
    v_cvt_pk_bf16_f32 v117, v106, v107
    v_cvt_pk_bf16_f32 v118, v108, v109
    v_cvt_pk_bf16_f32 v119, v110, v111
    v_mul_f32 v32, v32, v198
    v_mul_f32 v33, v33, v198
    v_mul_f32 v34, v34, v198
    v_mul_f32 v35, v35, v198
    v_mul_f32 v36, v36, v198
    v_mul_f32 v37, v37, v198
    v_mul_f32 v38, v38, v198
    v_mul_f32 v39, v39, v198
    v_mul_f32 v40, v40, v198
    v_mul_f32 v41, v41, v198
    v_mul_f32 v42, v42, v198
    v_mul_f32 v43, v43, v198
    v_mul_f32 v44, v44, v198
    v_mul_f32 v45, v45, v198
    v_mul_f32 v46, v46, v198
    v_mul_f32 v47, v47, v198
    v_mul_f32 v48, v48, v198
    v_mul_f32 v49, v49, v198
    v_mul_f32 v50, v50, v198
    v_mul_f32 v51, v51, v198
    v_mul_f32 v52, v52, v198
    v_mul_f32 v53, v53, v198
    v_mul_f32 v54, v54, v198
    v_mul_f32 v55, v55, v198
    v_mul_f32 v56, v56, v198
    v_mul_f32 v57, v57, v198
    v_mul_f32 v58, v58, v198
    v_mul_f32 v59, v59, v198
    v_mul_f32 v60, v60, v198
    v_mul_f32 v61, v61, v198
    v_mul_f32 v62, v62, v198
    v_mul_f32 v63, v63, v198
    v_mul_f32 v64, v64, v198
    v_mul_f32 v65, v65, v198
    v_mul_f32 v66, v66, v198
    v_mul_f32 v67, v67, v198
    v_mul_f32 v68, v68, v198
    v_mul_f32 v69, v69, v198
    v_mul_f32 v70, v70, v198
    v_mul_f32 v71, v71, v198
    v_mul_f32 v72, v72, v198
    v_mul_f32 v73, v73, v198
    v_mul_f32 v74, v74, v198
    v_mul_f32 v75, v75, v198
    v_mul_f32 v76, v76, v198
    v_mul_f32 v77, v77, v198
    v_mul_f32 v78, v78, v198
    v_mul_f32 v79, v79, v198
    v_mul_f32 v80, v80, v198
    v_mul_f32 v81, v81, v198
    v_mul_f32 v82, v82, v198
    v_mul_f32 v83, v83, v198
    v_mul_f32 v84, v84, v198
    v_mul_f32 v85, v85, v198
    v_mul_f32 v86, v86, v198
    v_mul_f32 v87, v87, v198
    v_mul_f32 v88, v88, v198
    v_mul_f32 v89, v89, v198
    v_mul_f32 v90, v90, v198
    v_mul_f32 v91, v91, v198
    v_mul_f32 v92, v92, v198
    v_mul_f32 v93, v93, v198
    v_mul_f32 v94, v94, v198
    v_mul_f32 v95, v95, v198
    s_waitcnt lgkmcnt(0)
    s_nop 1
    v_mfma_f32_32x32x16_bf16 v[32:47], v[120:123], v[112:115], v[32:47]
    v_mfma_f32_32x32x16_bf16 v[48:63], v[124:127], v[112:115], v[48:63]
    v_mfma_f32_32x32x16_bf16 v[64:79], v[128:131], v[112:115], v[64:79]
    v_mfma_f32_32x32x16_bf16 v[80:95], v[132:135], v[112:115], v[80:95]
    v_mfma_f32_32x32x16_bf16 v[32:47], v[136:139], v[116:119], v[32:47]
    v_mfma_f32_32x32x16_bf16 v[48:63], v[140:143], v[116:119], v[48:63]
    v_mfma_f32_32x32x16_bf16 v[64:79], v[144:147], v[116:119], v[64:79]
    v_mfma_f32_32x32x16_bf16 v[80:95], v[148:151], v[116:119], v[80:95]
    s_barrier
    ds_read_b128 v[120:123], v176 offset:49152
    ds_read_b128 v[124:127], v177 offset:49152
    ds_read_b128 v[128:131], v178 offset:49152
    ds_read_b128 v[132:135], v179 offset:49152
    ds_read_b128 v[136:139], v180 offset:49152
    ds_read_b128 v[140:143], v181 offset:49152
    ds_read_b128 v[144:147], v182 offset:49152
    ds_read_b128 v[148:151], v183 offset:49152
    s_waitcnt lgkmcnt(0)
    v_mfma_f32_32x32x16_bf16 v[96:111], v[120:123], v[0:3], 0
    v_mfma_f32_32x32x16_bf16 v[96:111], v[124:127], v[4:7], v[96:111]
    v_mfma_f32_32x32x16_bf16 v[96:111], v[128:131], v[8:11], v[96:111]
    v_mfma_f32_32x32x16_bf16 v[96:111], v[132:135], v[12:15], v[96:111]
    v_mfma_f32_32x32x16_bf16 v[96:111], v[136:139], v[16:19], v[96:111]
    v_mfma_f32_32x32x16_bf16 v[96:111], v[140:143], v[20:23], v[96:111]
    v_mfma_f32_32x32x16_bf16 v[96:111], v[144:147], v[24:27], v[96:111]
    v_mfma_f32_32x32x16_bf16 v[96:111], v[148:151], v[28:31], v[96:111]
    s_barrier
    ds_read_b64_tr_b16 v[120:121], v184 offset:57344
    ds_read_b64_tr_b16 v[122:123], v184 offset:59392
    ds_read_b64_tr_b16 v[124:125], v185 offset:57344
    ds_read_b64_tr_b16 v[126:127], v185 offset:59392
    ds_read_b64_tr_b16 v[128:129], v186 offset:57344
    ds_read_b64_tr_b16 v[130:131], v186 offset:59392
    ds_read_b64_tr_b16 v[132:133], v187 offset:57344
    ds_read_b64_tr_b16 v[134:135], v187 offset:59392
    ds_read_b64_tr_b16 v[136:137], v184 offset:61440
    ds_read_b64_tr_b16 v[138:139], v184 offset:63488
    ds_read_b64_tr_b16 v[140:141], v185 offset:61440
    ds_read_b64_tr_b16 v[142:143], v185 offset:63488
    ds_read_b64_tr_b16 v[144:145], v186 offset:61440
    ds_read_b64_tr_b16 v[146:147], v186 offset:63488
    ds_read_b64_tr_b16 v[148:149], v187 offset:61440
    ds_read_b64_tr_b16 v[150:151], v187 offset:63488
    s_nop 7
    v_max3_f32 v195, v96, v97, v98
    v_max3_f32 v195, v195, v99, v100
    v_max3_f32 v195, v195, v101, v102
    v_max3_f32 v195, v195, v103, v104
    v_max3_f32 v195, v195, v105, v106
    v_max3_f32 v195, v195, v107, v108
    v_max3_f32 v195, v195, v109, v110
    v_max_f32 v195, v195, v111
    v_mov_b32 v196, v195
    s_nop 1
    v_permlane32_swap_b32 v195, v196
    s_nop 1
    v_max3_f32 v195, v195, v196, v193
    v_sub_f32 v196, v193, v195
    v_mul_f32 v196, s44, v196
    v_exp_f32 v198, v196
    v_mov_b32 v193, v195
    v_mul_f32 v195, s44, v195
    v_fma_f32 v96, v96, s44, -v195
    v_fma_f32 v97, v97, s44, -v195
    v_fma_f32 v98, v98, s44, -v195
    v_fma_f32 v99, v99, s44, -v195
    v_fma_f32 v100, v100, s44, -v195
    v_fma_f32 v101, v101, s44, -v195
    v_fma_f32 v102, v102, s44, -v195
    v_fma_f32 v103, v103, s44, -v195
    v_fma_f32 v104, v104, s44, -v195
    v_fma_f32 v105, v105, s44, -v195
    v_fma_f32 v106, v106, s44, -v195
    v_fma_f32 v107, v107, s44, -v195
    v_fma_f32 v108, v108, s44, -v195
    v_fma_f32 v109, v109, s44, -v195
    v_fma_f32 v110, v110, s44, -v195
    v_fma_f32 v111, v111, s44, -v195
    v_exp_f32 v96, v96
    v_exp_f32 v97, v97
    v_exp_f32 v98, v98
    v_exp_f32 v99, v99
    v_exp_f32 v100, v100
    v_exp_f32 v101, v101
    v_exp_f32 v102, v102
    v_exp_f32 v103, v103
    v_exp_f32 v104, v104
    v_exp_f32 v105, v105
    v_exp_f32 v106, v106
    v_exp_f32 v107, v107
    v_exp_f32 v108, v108
    v_exp_f32 v109, v109
    v_exp_f32 v110, v110
    v_exp_f32 v111, v111
    v_mul_f32 v194, v194, v198
    v_add_f32 v194, v194, v96
    v_add_f32 v194, v194, v97
    v_add_f32 v194, v194, v98
    v_add_f32 v194, v194, v99
    v_add_f32 v194, v194, v100
    v_add_f32 v194, v194, v101
    v_add_f32 v194, v194, v102
    v_add_f32 v194, v194, v103
    v_add_f32 v194, v194, v104
    v_add_f32 v194, v194, v105
    v_add_f32 v194, v194, v106
    v_add_f32 v194, v194, v107
    v_add_f32 v194, v194, v108
    v_add_f32 v194, v194, v109
    v_add_f32 v194, v194, v110
    v_add_f32 v194, v194, v111
    v_cvt_pk_bf16_f32 v112, v96, v97
    v_cvt_pk_bf16_f32 v113, v98, v99
    v_cvt_pk_bf16_f32 v114, v100, v101
    v_cvt_pk_bf16_f32 v115, v102, v103
    v_cvt_pk_bf16_f32 v116, v104, v105
    v_cvt_pk_bf16_f32 v117, v106, v107
    v_cvt_pk_bf16_f32 v118, v108, v109
    v_cvt_pk_bf16_f32 v119, v110, v111
    v_mul_f32 v32, v32, v198
    v_mul_f32 v33, v33, v198
    v_mul_f32 v34, v34, v198
    v_mul_f32 v35, v35, v198
    v_mul_f32 v36, v36, v198
    v_mul_f32 v37, v37, v198
    v_mul_f32 v38, v38, v198
    v_mul_f32 v39, v39, v198
    v_mul_f32 v40, v40, v198
    v_mul_f32 v41, v41, v198
    v_mul_f32 v42, v42, v198
    v_mul_f32 v43, v43, v198
    v_mul_f32 v44, v44, v198
    v_mul_f32 v45, v45, v198
    v_mul_f32 v46, v46, v198
    v_mul_f32 v47, v47, v198
    v_mul_f32 v48, v48, v198
    v_mul_f32 v49, v49, v198
    v_mul_f32 v50, v50, v198
    v_mul_f32 v51, v51, v198
    v_mul_f32 v52, v52, v198
    v_mul_f32 v53, v53, v198
    v_mul_f32 v54, v54, v198
    v_mul_f32 v55, v55, v198
    v_mul_f32 v56, v56, v198
    v_mul_f32 v57, v57, v198
    v_mul_f32 v58, v58, v198
    v_mul_f32 v59, v59, v198
    v_mul_f32 v60, v60, v198
    v_mul_f32 v61, v61, v198
    v_mul_f32 v62, v62, v198
    v_mul_f32 v63, v63, v198
    v_mul_f32 v64, v64, v198
    v_mul_f32 v65, v65, v198
    v_mul_f32 v66, v66, v198
    v_mul_f32 v67, v67, v198
    v_mul_f32 v68, v68, v198
    v_mul_f32 v69, v69, v198
    v_mul_f32 v70, v70, v198
    v_mul_f32 v71, v71, v198
    v_mul_f32 v72, v72, v198
    v_mul_f32 v73, v73, v198
    v_mul_f32 v74, v74, v198
    v_mul_f32 v75, v75, v198
    v_mul_f32 v76, v76, v198
    v_mul_f32 v77, v77, v198
    v_mul_f32 v78, v78, v198
    v_mul_f32 v79, v79, v198
    v_mul_f32 v80, v80, v198
    v_mul_f32 v81, v81, v198
    v_mul_f32 v82, v82, v198
    v_mul_f32 v83, v83, v198
    v_mul_f32 v84, v84, v198
    v_mul_f32 v85, v85, v198
    v_mul_f32 v86, v86, v198
    v_mul_f32 v87, v87, v198
    v_mul_f32 v88, v88, v198
    v_mul_f32 v89, v89, v198
    v_mul_f32 v90, v90, v198
    v_mul_f32 v91, v91, v198
    v_mul_f32 v92, v92, v198
    v_mul_f32 v93, v93, v198
    v_mul_f32 v94, v94, v198
    v_mul_f32 v95, v95, v198
    s_waitcnt lgkmcnt(0)
    s_nop 1
    v_mfma_f32_32x32x16_bf16 v[32:47], v[120:123], v[112:115], v[32:47]
    v_mfma_f32_32x32x16_bf16 v[48:63], v[124:127], v[112:115], v[48:63]
    v_mfma_f32_32x32x16_bf16 v[64:79], v[128:131], v[112:115], v[64:79]
    v_mfma_f32_32x32x16_bf16 v[80:95], v[132:135], v[112:115], v[80:95]
    v_mfma_f32_32x32x16_bf16 v[32:47], v[136:139], v[116:119], v[32:47]
    v_mfma_f32_32x32x16_bf16 v[48:63], v[140:143], v[116:119], v[48:63]
    v_mfma_f32_32x32x16_bf16 v[64:79], v[144:147], v[116:119], v[64:79]
    v_mfma_f32_32x32x16_bf16 v[80:95], v[148:151], v[116:119], v[80:95]
    s_nop 15
    v_mov_b32 v196, v194
    s_nop 1
    v_permlane32_swap_b32 v194, v196
    s_nop 1
    v_add_f32 v194, v194, v196
    v_rcp_f32 v194, v194
    s_nop 1
    v_mul_f32 v32, v32, v194
    v_mul_f32 v33, v33, v194
    v_mul_f32 v34, v34, v194
    v_mul_f32 v35, v35, v194
    v_mul_f32 v36, v36, v194
    v_mul_f32 v37, v37, v194
    v_mul_f32 v38, v38, v194
    v_mul_f32 v39, v39, v194
    v_mul_f32 v40, v40, v194
    v_mul_f32 v41, v41, v194
    v_mul_f32 v42, v42, v194
    v_mul_f32 v43, v43, v194
    v_mul_f32 v44, v44, v194
    v_mul_f32 v45, v45, v194
    v_mul_f32 v46, v46, v194
    v_mul_f32 v47, v47, v194
    v_mul_f32 v48, v48, v194
    v_mul_f32 v49, v49, v194
    v_mul_f32 v50, v50, v194
    v_mul_f32 v51, v51, v194
    v_mul_f32 v52, v52, v194
    v_mul_f32 v53, v53, v194
    v_mul_f32 v54, v54, v194
    v_mul_f32 v55, v55, v194
    v_mul_f32 v56, v56, v194
    v_mul_f32 v57, v57, v194
    v_mul_f32 v58, v58, v194
    v_mul_f32 v59, v59, v194
    v_mul_f32 v60, v60, v194
    v_mul_f32 v61, v61, v194
    v_mul_f32 v62, v62, v194
    v_mul_f32 v63, v63, v194
    v_mul_f32 v64, v64, v194
    v_mul_f32 v65, v65, v194
    v_mul_f32 v66, v66, v194
    v_mul_f32 v67, v67, v194
    v_mul_f32 v68, v68, v194
    v_mul_f32 v69, v69, v194
    v_mul_f32 v70, v70, v194
    v_mul_f32 v71, v71, v194
    v_mul_f32 v72, v72, v194
    v_mul_f32 v73, v73, v194
    v_mul_f32 v74, v74, v194
    v_mul_f32 v75, v75, v194
    v_mul_f32 v76, v76, v194
    v_mul_f32 v77, v77, v194
    v_mul_f32 v78, v78, v194
    v_mul_f32 v79, v79, v194
    v_mul_f32 v80, v80, v194
    v_mul_f32 v81, v81, v194
    v_mul_f32 v82, v82, v194
    v_mul_f32 v83, v83, v194
    v_mul_f32 v84, v84, v194
    v_mul_f32 v85, v85, v194
    v_mul_f32 v86, v86, v194
    v_mul_f32 v87, v87, v194
    v_mul_f32 v88, v88, v194
    v_mul_f32 v89, v89, v194
    v_mul_f32 v90, v90, v194
    v_mul_f32 v91, v91, v194
    v_mul_f32 v92, v92, v194
    v_mul_f32 v93, v93, v194
    v_mul_f32 v94, v94, v194
    v_mul_f32 v95, v95, v194
    v_cvt_pk_bf16_f32 v0, v32, v33
    v_cvt_pk_bf16_f32 v1, v34, v35
    v_cvt_pk_bf16_f32 v2, v36, v37
    v_cvt_pk_bf16_f32 v3, v38, v39
    buffer_store_dwordx4 v[0:3], v199, s[36:39], 0 offen offset:0
    v_cvt_pk_bf16_f32 v4, v40, v41
    v_cvt_pk_bf16_f32 v5, v42, v43
    v_cvt_pk_bf16_f32 v6, v44, v45
    v_cvt_pk_bf16_f32 v7, v46, v47
    buffer_store_dwordx4 v[4:7], v199, s[36:39], 0 offen offset:32
    v_cvt_pk_bf16_f32 v8, v48, v49
    v_cvt_pk_bf16_f32 v9, v50, v51
    v_cvt_pk_bf16_f32 v10, v52, v53
    v_cvt_pk_bf16_f32 v11, v54, v55
    buffer_store_dwordx4 v[8:11], v199, s[36:39], 0 offen offset:64
    v_cvt_pk_bf16_f32 v12, v56, v57
    v_cvt_pk_bf16_f32 v13, v58, v59
    v_cvt_pk_bf16_f32 v14, v60, v61
    v_cvt_pk_bf16_f32 v15, v62, v63
    buffer_store_dwordx4 v[12:15], v199, s[36:39], 0 offen offset:96
    v_cvt_pk_bf16_f32 v16, v64, v65
    v_cvt_pk_bf16_f32 v17, v66, v67
    v_cvt_pk_bf16_f32 v18, v68, v69
    v_cvt_pk_bf16_f32 v19, v70, v71
    buffer_store_dwordx4 v[16:19], v199, s[36:39], 0 offen offset:128
    v_cvt_pk_bf16_f32 v20, v72, v73
    v_cvt_pk_bf16_f32 v21, v74, v75
    v_cvt_pk_bf16_f32 v22, v76, v77
    v_cvt_pk_bf16_f32 v23, v78, v79
    buffer_store_dwordx4 v[20:23], v199, s[36:39], 0 offen offset:160
    v_cvt_pk_bf16_f32 v24, v80, v81
    v_cvt_pk_bf16_f32 v25, v82, v83
    v_cvt_pk_bf16_f32 v26, v84, v85
    v_cvt_pk_bf16_f32 v27, v86, v87
    buffer_store_dwordx4 v[24:27], v199, s[36:39], 0 offen offset:192
    v_cvt_pk_bf16_f32 v28, v88, v89
    v_cvt_pk_bf16_f32 v29, v90, v91
    v_cvt_pk_bf16_f32 v30, v92, v93
    v_cvt_pk_bf16_f32 v31, v94, v95
    buffer_store_dwordx4 v[28:31], v199, s[36:39], 0 offen offset:224
    s_branch A_end
A_prod:
    s_mul_i32 s46, s2, 5
    s_lshr_b32 s47, s2, 4
    s_add_u32 s46, s46, s47
    s_and_b32 s46, s46, 15
    v_lshrrev_b32 v2, 4, v200
    v_and_b32 v3, 15, v200
    s_mov_b32 s42, 8192
    v_lshlrev_b32 v4, 2, v2
    v_xor_b32 v4, v4, v3
    v_lshlrev_b32 v4, 4, v4
    v_add_u32 v5, 0, v2
    v_and_b32 v6, 15, v5
    v_xor_b32 v6, v6, v3
    v_lshlrev_b32 v6, 4, v6
    v_lshl_add_u32 v8, v5, 8, v6
    v_lshl_add_u32 v16, v5, 8, v4
    v_mul_lo_u32 v6, v5, s42
    v_add_u32 v24, v6, v4
    v_add_u32 v5, 4, v2
    v_and_b32 v6, 15, v5
    v_xor_b32 v6, v6, v3
    v_lshlrev_b32 v6, 4, v6
    v_lshl_add_u32 v9, v5, 8, v6
    v_lshl_add_u32 v17, v5, 8, v4
    v_mul_lo_u32 v6, v5, s42
    v_add_u32 v25, v6, v4
    v_add_u32 v5, 8, v2
    v_and_b32 v6, 15, v5
    v_xor_b32 v6, v6, v3
    v_lshlrev_b32 v6, 4, v6
    v_lshl_add_u32 v10, v5, 8, v6
    v_lshl_add_u32 v18, v5, 8, v4
    v_mul_lo_u32 v6, v5, s42
    v_add_u32 v26, v6, v4
    v_add_u32 v5, 12, v2
    v_and_b32 v6, 15, v5
    v_xor_b32 v6, v6, v3
    v_lshlrev_b32 v6, 4, v6
    v_lshl_add_u32 v11, v5, 8, v6
    v_lshl_add_u32 v19, v5, 8, v4
    v_mul_lo_u32 v6, v5, s42
    v_add_u32 v27, v6, v4
    v_add_u32 v5, 16, v2
    v_and_b32 v6, 15, v5
    v_xor_b32 v6, v6, v3
    v_lshlrev_b32 v6, 4, v6
    v_lshl_add_u32 v12, v5, 8, v6
    v_lshl_add_u32 v20, v5, 8, v4
    v_mul_lo_u32 v6, v5, s42
    v_add_u32 v28, v6, v4
    v_add_u32 v5, 20, v2
    v_and_b32 v6, 15, v5
    v_xor_b32 v6, v6, v3
    v_lshlrev_b32 v6, 4, v6
    v_lshl_add_u32 v13, v5, 8, v6
    v_lshl_add_u32 v21, v5, 8, v4
    v_mul_lo_u32 v6, v5, s42
    v_add_u32 v29, v6, v4
    v_add_u32 v5, 24, v2
    v_and_b32 v6, 15, v5
    v_xor_b32 v6, v6, v3
    v_lshlrev_b32 v6, 4, v6
    v_lshl_add_u32 v14, v5, 8, v6
    v_lshl_add_u32 v22, v5, 8, v4
    v_mul_lo_u32 v6, v5, s42
    v_add_u32 v30, v6, v4
    v_add_u32 v5, 28, v2
    v_and_b32 v6, 15, v5
    v_xor_b32 v6, v6, v3
    v_lshlrev_b32 v6, 4, v6
    v_lshl_add_u32 v15, v5, 8, v6
    v_lshl_add_u32 v23, v5, 8, v4
    v_mul_lo_u32 v6, v5, s42
    v_add_u32 v31, v6, v4
    s_mov_b32 s41, 0
    s_mov_b32 m0, 0
    s_nop 0
    buffer_load_dwordx4 v24, s[28:31], s41 offen lds
    s_mov_b32 m0, 1024
    s_nop 0
    buffer_load_dwordx4 v25, s[28:31], s41 offen lds
    s_mov_b32 m0, 2048
    s_nop 0
    buffer_load_dwordx4 v26, s[28:31], s41 offen lds
    s_mov_b32 m0, 3072
    s_nop 0
    buffer_load_dwordx4 v27, s[28:31], s41 offen lds
    s_mov_b32 m0, 4096
    s_nop 0
    buffer_load_dwordx4 v28, s[28:31], s41 offen lds
    s_mov_b32 m0, 5120
    s_nop 0
    buffer_load_dwordx4 v29, s[28:31], s41 offen lds
    s_mov_b32 m0, 6144
    s_nop 0
    buffer_load_dwordx4 v30, s[28:31], s41 offen lds
    s_mov_b32 m0, 7168
    s_nop 0
    buffer_load_dwordx4 v31, s[28:31], s41 offen lds
    s_mov_b32 s41, 262144
    s_mov_b32 m0, 8192
    s_nop 0
    buffer_load_dwordx4 v24, s[28:31], s41 offen lds
    s_mov_b32 m0, 9216
    s_nop 0
    buffer_load_dwordx4 v25, s[28:31], s41 offen lds
    s_mov_b32 m0, 10240
    s_nop 0
    buffer_load_dwordx4 v26, s[28:31], s41 offen lds
    s_mov_b32 m0, 11264
    s_nop 0
    buffer_load_dwordx4 v27, s[28:31], s41 offen lds
    s_mov_b32 m0, 12288
    s_nop 0
    buffer_load_dwordx4 v28, s[28:31], s41 offen lds
    s_mov_b32 m0, 13312
    s_nop 0
    buffer_load_dwordx4 v29, s[28:31], s41 offen lds
    s_mov_b32 m0, 14336
    s_nop 0
    buffer_load_dwordx4 v30, s[28:31], s41 offen lds
    s_mov_b32 m0, 15360
    s_nop 0
    buffer_load_dwordx4 v31, s[28:31], s41 offen lds
    s_mov_b32 s41, 524288
    s_mov_b32 m0, 16384
    s_nop 0
    buffer_load_dwordx4 v24, s[28:31], s41 offen lds
    s_mov_b32 m0, 17408
    s_nop 0
    buffer_load_dwordx4 v25, s[28:31], s41 offen lds
    s_mov_b32 m0, 18432
    s_nop 0
    buffer_load_dwordx4 v26, s[28:31], s41 offen lds
    s_mov_b32 m0, 19456
    s_nop 0
    buffer_load_dwordx4 v27, s[28:31], s41 offen lds
    s_mov_b32 m0, 20480
    s_nop 0
    buffer_load_dwordx4 v28, s[28:31], s41 offen lds
    s_mov_b32 m0, 21504
    s_nop 0
    buffer_load_dwordx4 v29, s[28:31], s41 offen lds
    s_mov_b32 m0, 22528
    s_nop 0
    buffer_load_dwordx4 v30, s[28:31], s41 offen lds
    s_mov_b32 m0, 23552
    s_nop 0
    buffer_load_dwordx4 v31, s[28:31], s41 offen lds
    s_mov_b32 s41, 786432
    s_mov_b32 m0, 24576
    s_nop 0
    buffer_load_dwordx4 v24, s[28:31], s41 offen lds
    s_mov_b32 m0, 25600
    s_nop 0
    buffer_load_dwordx4 v25, s[28:31], s41 offen lds
    s_mov_b32 m0, 26624
    s_nop 0
    buffer_load_dwordx4 v26, s[28:31], s41 offen lds
    s_mov_b32 m0, 27648
    s_nop 0
    buffer_load_dwordx4 v27, s[28:31], s41 offen lds
    s_mov_b32 m0, 28672
    s_nop 0
    buffer_load_dwordx4 v28, s[28:31], s41 offen lds
    s_mov_b32 m0, 29696
    s_nop 0
    buffer_load_dwordx4 v29, s[28:31], s41 offen lds
    s_mov_b32 m0, 30720
    s_nop 0
    buffer_load_dwordx4 v30, s[28:31], s41 offen lds
    s_mov_b32 m0, 31744
    s_nop 0
    buffer_load_dwordx4 v31, s[28:31], s41 offen lds
    s_mov_b32 s41, 1048576
    s_mov_b32 m0, 32768
    s_nop 0
    buffer_load_dwordx4 v24, s[28:31], s41 offen lds
    s_mov_b32 m0, 33792
    s_nop 0
    buffer_load_dwordx4 v25, s[28:31], s41 offen lds
    s_mov_b32 m0, 34816
    s_nop 0
    buffer_load_dwordx4 v26, s[28:31], s41 offen lds
    s_mov_b32 m0, 35840
    s_nop 0
    buffer_load_dwordx4 v27, s[28:31], s41 offen lds
    s_mov_b32 m0, 36864
    s_nop 0
    buffer_load_dwordx4 v28, s[28:31], s41 offen lds
    s_mov_b32 m0, 37888
    s_nop 0
    buffer_load_dwordx4 v29, s[28:31], s41 offen lds
    s_mov_b32 m0, 38912
    s_nop 0
    buffer_load_dwordx4 v30, s[28:31], s41 offen lds
    s_mov_b32 m0, 39936
    s_nop 0
    buffer_load_dwordx4 v31, s[28:31], s41 offen lds
    s_mov_b32 s41, 1310720
    s_mov_b32 m0, 40960
    s_nop 0
    buffer_load_dwordx4 v24, s[28:31], s41 offen lds
    s_mov_b32 m0, 41984
    s_nop 0
    buffer_load_dwordx4 v25, s[28:31], s41 offen lds
    s_mov_b32 m0, 43008
    s_nop 0
    buffer_load_dwordx4 v26, s[28:31], s41 offen lds
    s_mov_b32 m0, 44032
    s_nop 0
    buffer_load_dwordx4 v27, s[28:31], s41 offen lds
    s_mov_b32 m0, 45056
    s_nop 0
    buffer_load_dwordx4 v28, s[28:31], s41 offen lds
    s_mov_b32 m0, 46080
    s_nop 0
    buffer_load_dwordx4 v29, s[28:31], s41 offen lds
    s_mov_b32 m0, 47104
    s_nop 0
    buffer_load_dwordx4 v30, s[28:31], s41 offen lds
    s_mov_b32 m0, 48128
    s_nop 0
    buffer_load_dwordx4 v31, s[28:31], s41 offen lds
    s_mov_b32 s41, 1572864
    s_mov_b32 m0, 49152
    s_nop 0
    buffer_load_dwordx4 v24, s[28:31], s41 offen lds
    s_mov_b32 m0, 50176
    s_nop 0
    buffer_load_dwordx4 v25, s[28:31], s41 offen lds
    s_mov_b32 m0, 51200
    s_nop 0
    buffer_load_dwordx4 v26, s[28:31], s41 offen lds
    s_mov_b32 m0, 52224
    s_nop 0
    buffer_load_dwordx4 v27, s[28:31], s41 offen lds
    s_mov_b32 m0, 53248
    s_nop 0
    buffer_load_dwordx4 v28, s[28:31], s41 offen lds
    s_mov_b32 m0, 54272
    s_nop 0
    buffer_load_dwordx4 v29, s[28:31], s41 offen lds
    s_mov_b32 m0, 55296
    s_nop 0
    buffer_load_dwordx4 v30, s[28:31], s41 offen lds
    s_mov_b32 m0, 56320
    s_nop 0
    buffer_load_dwordx4 v31, s[28:31], s41 offen lds
    s_waitcnt vmcnt(48)
    s_barrier
    s_mov_b32 s41, 1835008
    s_mov_b32 m0, 57344
    s_nop 0
    buffer_load_dwordx4 v24, s[28:31], s41 offen lds
    s_mov_b32 m0, 58368
    s_nop 0
    buffer_load_dwordx4 v25, s[28:31], s41 offen lds
    s_mov_b32 m0, 59392
    s_nop 0
    buffer_load_dwordx4 v26, s[28:31], s41 offen lds
    s_mov_b32 m0, 60416
    s_nop 0
    buffer_load_dwordx4 v27, s[28:31], s41 offen lds
    s_mov_b32 m0, 61440
    s_nop 0
    buffer_load_dwordx4 v28, s[28:31], s41 offen lds
    s_mov_b32 m0, 62464
    s_nop 0
    buffer_load_dwordx4 v29, s[28:31], s41 offen lds
    s_mov_b32 m0, 63488
    s_nop 0
    buffer_load_dwordx4 v30, s[28:31], s41 offen lds
    s_mov_b32 m0, 64512
    s_nop 0
    buffer_load_dwordx4 v31, s[28:31], s41 offen lds
    s_waitcnt vmcnt(48)
    s_barrier
    s_mov_b32 s41, 2097152
    s_mov_b32 m0, 0
    s_nop 0
    buffer_load_dwordx4 v24, s[28:31], s41 offen lds
    s_mov_b32 m0, 1024
    s_nop 0
    buffer_load_dwordx4 v25, s[28:31], s41 offen lds
    s_mov_b32 m0, 2048
    s_nop 0
    buffer_load_dwordx4 v26, s[28:31], s41 offen lds
    s_mov_b32 m0, 3072
    s_nop 0
    buffer_load_dwordx4 v27, s[28:31], s41 offen lds
    s_mov_b32 m0, 4096
    s_nop 0
    buffer_load_dwordx4 v28, s[28:31], s41 offen lds
    s_mov_b32 m0, 5120
    s_nop 0
    buffer_load_dwordx4 v29, s[28:31], s41 offen lds
    s_mov_b32 m0, 6144
    s_nop 0
    buffer_load_dwordx4 v30, s[28:31], s41 offen lds
    s_mov_b32 m0, 7168
    s_nop 0
    buffer_load_dwordx4 v31, s[28:31], s41 offen lds
    s_waitcnt vmcnt(48)
    s_barrier
    s_mov_b32 s41, 2359296
    s_mov_b32 m0, 8192
    s_nop 0
    buffer_load_dwordx4 v24, s[28:31], s41 offen lds
    s_mov_b32 m0, 9216
    s_nop 0
    buffer_load_dwordx4 v25, s[28:31], s41 offen lds
    s_mov_b32 m0, 10240
    s_nop 0
    buffer_load_dwordx4 v26, s[28:31], s41 offen lds
    s_mov_b32 m0, 11264
    s_nop 0
    buffer_load_dwordx4 v27, s[28:31], s41 offen lds
    s_mov_b32 m0, 12288
    s_nop 0
    buffer_load_dwordx4 v28, s[28:31], s41 offen lds
    s_mov_b32 m0, 13312
    s_nop 0
    buffer_load_dwordx4 v29, s[28:31], s41 offen lds
    s_mov_b32 m0, 14336
    s_nop 0
    buffer_load_dwordx4 v30, s[28:31], s41 offen lds
    s_mov_b32 m0, 15360
    s_nop 0
    buffer_load_dwordx4 v31, s[28:31], s41 offen lds
    s_waitcnt vmcnt(48)
    s_barrier
    s_mov_b32 s41, 2621440
    s_mov_b32 m0, 16384
    s_nop 0
    buffer_load_dwordx4 v24, s[28:31], s41 offen lds
    s_mov_b32 m0, 17408
    s_nop 0
    buffer_load_dwordx4 v25, s[28:31], s41 offen lds
    s_mov_b32 m0, 18432
    s_nop 0
    buffer_load_dwordx4 v26, s[28:31], s41 offen lds
    s_mov_b32 m0, 19456
    s_nop 0
    buffer_load_dwordx4 v27, s[28:31], s41 offen lds
    s_mov_b32 m0, 20480
    s_nop 0
    buffer_load_dwordx4 v28, s[28:31], s41 offen lds
    s_mov_b32 m0, 21504
    s_nop 0
    buffer_load_dwordx4 v29, s[28:31], s41 offen lds
    s_mov_b32 m0, 22528
    s_nop 0
    buffer_load_dwordx4 v30, s[28:31], s41 offen lds
    s_mov_b32 m0, 23552
    s_nop 0
    buffer_load_dwordx4 v31, s[28:31], s41 offen lds
    s_waitcnt vmcnt(48)
    s_barrier
    s_mov_b32 s41, 2883584
    s_mov_b32 m0, 24576
    s_nop 0
    buffer_load_dwordx4 v24, s[28:31], s41 offen lds
    s_mov_b32 m0, 25600
    s_nop 0
    buffer_load_dwordx4 v25, s[28:31], s41 offen lds
    s_mov_b32 m0, 26624
    s_nop 0
    buffer_load_dwordx4 v26, s[28:31], s41 offen lds
    s_mov_b32 m0, 27648
    s_nop 0
    buffer_load_dwordx4 v27, s[28:31], s41 offen lds
    s_mov_b32 m0, 28672
    s_nop 0
    buffer_load_dwordx4 v28, s[28:31], s41 offen lds
    s_mov_b32 m0, 29696
    s_nop 0
    buffer_load_dwordx4 v29, s[28:31], s41 offen lds
    s_mov_b32 m0, 30720
    s_nop 0
    buffer_load_dwordx4 v30, s[28:31], s41 offen lds
    s_mov_b32 m0, 31744
    s_nop 0
    buffer_load_dwordx4 v31, s[28:31], s41 offen lds
    s_waitcnt vmcnt(48)
    s_barrier
    s_mov_b32 s41, 3145728
    s_mov_b32 m0, 32768
    s_nop 0
    buffer_load_dwordx4 v24, s[28:31], s41 offen lds
    s_mov_b32 m0, 33792
    s_nop 0
    buffer_load_dwordx4 v25, s[28:31], s41 offen lds
    s_mov_b32 m0, 34816
    s_nop 0
    buffer_load_dwordx4 v26, s[28:31], s41 offen lds
    s_mov_b32 m0, 35840
    s_nop 0
    buffer_load_dwordx4 v27, s[28:31], s41 offen lds
    s_mov_b32 m0, 36864
    s_nop 0
    buffer_load_dwordx4 v28, s[28:31], s41 offen lds
    s_mov_b32 m0, 37888
    s_nop 0
    buffer_load_dwordx4 v29, s[28:31], s41 offen lds
    s_mov_b32 m0, 38912
    s_nop 0
    buffer_load_dwordx4 v30, s[28:31], s41 offen lds
    s_mov_b32 m0, 39936
    s_nop 0
    buffer_load_dwordx4 v31, s[28:31], s41 offen lds
    s_waitcnt vmcnt(48)
    s_barrier
    s_mov_b32 s41, 3407872
    s_mov_b32 m0, 40960
    s_nop 0
    buffer_load_dwordx4 v24, s[28:31], s41 offen lds
    s_mov_b32 m0, 41984
    s_nop 0
    buffer_load_dwordx4 v25, s[28:31], s41 offen lds
    s_mov_b32 m0, 43008
    s_nop 0
    buffer_load_dwordx4 v26, s[28:31], s41 offen lds
    s_mov_b32 m0, 44032
    s_nop 0
    buffer_load_dwordx4 v27, s[28:31], s41 offen lds
    s_mov_b32 m0, 45056
    s_nop 0
    buffer_load_dwordx4 v28, s[28:31], s41 offen lds
    s_mov_b32 m0, 46080
    s_nop 0
    buffer_load_dwordx4 v29, s[28:31], s41 offen lds
    s_mov_b32 m0, 47104
    s_nop 0
    buffer_load_dwordx4 v30, s[28:31], s41 offen lds
    s_mov_b32 m0, 48128
    s_nop 0
    buffer_load_dwordx4 v31, s[28:31], s41 offen lds
    s_waitcnt vmcnt(48)
    s_barrier
    s_mov_b32 s41, 3670016
    s_mov_b32 m0, 49152
    s_nop 0
    buffer_load_dwordx4 v24, s[28:31], s41 offen lds
    s_mov_b32 m0, 50176
    s_nop 0
    buffer_load_dwordx4 v25, s[28:31], s41 offen lds
    s_mov_b32 m0, 51200
    s_nop 0
    buffer_load_dwordx4 v26, s[28:31], s41 offen lds
    s_mov_b32 m0, 52224
    s_nop 0
    buffer_load_dwordx4 v27, s[28:31], s41 offen lds
    s_mov_b32 m0, 53248
    s_nop 0
    buffer_load_dwordx4 v28, s[28:31], s41 offen lds
    s_mov_b32 m0, 54272
    s_nop 0
    buffer_load_dwordx4 v29, s[28:31], s41 offen lds
    s_mov_b32 m0, 55296
    s_nop 0
    buffer_load_dwordx4 v30, s[28:31], s41 offen lds
    s_mov_b32 m0, 56320
    s_nop 0
    buffer_load_dwordx4 v31, s[28:31], s41 offen lds
    s_waitcnt vmcnt(48)
    s_barrier
    s_mov_b32 s41, 3932160
    s_mov_b32 m0, 57344
    s_nop 0
    buffer_load_dwordx4 v24, s[28:31], s41 offen lds
    s_mov_b32 m0, 58368
    s_nop 0
    buffer_load_dwordx4 v25, s[28:31], s41 offen lds
    s_mov_b32 m0, 59392
    s_nop 0
    buffer_load_dwordx4 v26, s[28:31], s41 offen lds
    s_mov_b32 m0, 60416
    s_nop 0
    buffer_load_dwordx4 v27, s[28:31], s41 offen lds
    s_mov_b32 m0, 61440
    s_nop 0
    buffer_load_dwordx4 v28, s[28:31], s41 offen lds
    s_mov_b32 m0, 62464
    s_nop 0
    buffer_load_dwordx4 v29, s[28:31], s41 offen lds
    s_mov_b32 m0, 63488
    s_nop 0
    buffer_load_dwordx4 v30, s[28:31], s41 offen lds
    s_mov_b32 m0, 64512
    s_nop 0
    buffer_load_dwordx4 v31, s[28:31], s41 offen lds
    s_waitcnt vmcnt(48)
    s_barrier
    s_mov_b32 s41, 0
    s_mov_b32 m0, 0
    s_nop 0
    buffer_load_dwordx4 v8, s[20:23], s41 offen lds
    s_mov_b32 m0, 1024
    s_nop 0
    buffer_load_dwordx4 v9, s[20:23], s41 offen lds
    s_mov_b32 m0, 2048
    s_nop 0
    buffer_load_dwordx4 v10, s[20:23], s41 offen lds
    s_mov_b32 m0, 3072
    s_nop 0
    buffer_load_dwordx4 v11, s[20:23], s41 offen lds
    s_mov_b32 m0, 4096
    s_nop 0
    buffer_load_dwordx4 v12, s[20:23], s41 offen lds
    s_mov_b32 m0, 5120
    s_nop 0
    buffer_load_dwordx4 v13, s[20:23], s41 offen lds
    s_mov_b32 m0, 6144
    s_nop 0
    buffer_load_dwordx4 v14, s[20:23], s41 offen lds
    s_mov_b32 m0, 7168
    s_nop 0
    buffer_load_dwordx4 v15, s[20:23], s41 offen lds
    s_waitcnt vmcnt(48)
    s_barrier
    s_mov_b32 s41, 0
    s_mov_b32 m0, 8192
    s_nop 0
    buffer_load_dwordx4 v16, s[24:27], s41 offen lds
    s_mov_b32 m0, 9216
    s_nop 0
    buffer_load_dwordx4 v17, s[24:27], s41 offen lds
    s_mov_b32 m0, 10240
    s_nop 0
    buffer_load_dwordx4 v18, s[24:27], s41 offen lds
    s_mov_b32 m0, 11264
    s_nop 0
    buffer_load_dwordx4 v19, s[24:27], s41 offen lds
    s_mov_b32 m0, 12288
    s_nop 0
    buffer_load_dwordx4 v20, s[24:27], s41 offen lds
    s_mov_b32 m0, 13312
    s_nop 0
    buffer_load_dwordx4 v21, s[24:27], s41 offen lds
    s_mov_b32 m0, 14336
    s_nop 0
    buffer_load_dwordx4 v22, s[24:27], s41 offen lds
    s_mov_b32 m0, 15360
    s_nop 0
    buffer_load_dwordx4 v23, s[24:27], s41 offen lds
    s_waitcnt vmcnt(48)
    s_barrier
    s_mov_b32 s41, 8192
    s_mov_b32 m0, 16384
    s_nop 0
    buffer_load_dwordx4 v8, s[20:23], s41 offen lds
    s_mov_b32 m0, 17408
    s_nop 0
    buffer_load_dwordx4 v9, s[20:23], s41 offen lds
    s_mov_b32 m0, 18432
    s_nop 0
    buffer_load_dwordx4 v10, s[20:23], s41 offen lds
    s_mov_b32 m0, 19456
    s_nop 0
    buffer_load_dwordx4 v11, s[20:23], s41 offen lds
    s_mov_b32 m0, 20480
    s_nop 0
    buffer_load_dwordx4 v12, s[20:23], s41 offen lds
    s_mov_b32 m0, 21504
    s_nop 0
    buffer_load_dwordx4 v13, s[20:23], s41 offen lds
    s_mov_b32 m0, 22528
    s_nop 0
    buffer_load_dwordx4 v14, s[20:23], s41 offen lds
    s_mov_b32 m0, 23552
    s_nop 0
    buffer_load_dwordx4 v15, s[20:23], s41 offen lds
    s_waitcnt vmcnt(48)
    s_barrier
    s_mov_b32 s41, 8192
    s_mov_b32 m0, 24576
    s_nop 0
    buffer_load_dwordx4 v16, s[24:27], s41 offen lds
    s_mov_b32 m0, 25600
    s_nop 0
    buffer_load_dwordx4 v17, s[24:27], s41 offen lds
    s_mov_b32 m0, 26624
    s_nop 0
    buffer_load_dwordx4 v18, s[24:27], s41 offen lds
    s_mov_b32 m0, 27648
    s_nop 0
    buffer_load_dwordx4 v19, s[24:27], s41 offen lds
    s_mov_b32 m0, 28672
    s_nop 0
    buffer_load_dwordx4 v20, s[24:27], s41 offen lds
    s_mov_b32 m0, 29696
    s_nop 0
    buffer_load_dwordx4 v21, s[24:27], s41 offen lds
    s_mov_b32 m0, 30720
    s_nop 0
    buffer_load_dwordx4 v22, s[24:27], s41 offen lds
    s_mov_b32 m0, 31744
    s_nop 0
    buffer_load_dwordx4 v23, s[24:27], s41 offen lds
    s_waitcnt vmcnt(48)
    s_barrier
    s_mov_b32 s41, 16384
    s_mov_b32 m0, 32768
    s_nop 0
    buffer_load_dwordx4 v8, s[20:23], s41 offen lds
    s_mov_b32 m0, 33792
    s_nop 0
    buffer_load_dwordx4 v9, s[20:23], s41 offen lds
    s_mov_b32 m0, 34816
    s_nop 0
    buffer_load_dwordx4 v10, s[20:23], s41 offen lds
    s_mov_b32 m0, 35840
    s_nop 0
    buffer_load_dwordx4 v11, s[20:23], s41 offen lds
    s_mov_b32 m0, 36864
    s_nop 0
    buffer_load_dwordx4 v12, s[20:23], s41 offen lds
    s_mov_b32 m0, 37888
    s_nop 0
    buffer_load_dwordx4 v13, s[20:23], s41 offen lds
    s_mov_b32 m0, 38912
    s_nop 0
    buffer_load_dwordx4 v14, s[20:23], s41 offen lds
    s_mov_b32 m0, 39936
    s_nop 0
    buffer_load_dwordx4 v15, s[20:23], s41 offen lds
    s_waitcnt vmcnt(48)
    s_barrier
    s_mov_b32 s41, 16384
    s_mov_b32 m0, 40960
    s_nop 0
    buffer_load_dwordx4 v16, s[24:27], s41 offen lds
    s_mov_b32 m0, 41984
    s_nop 0
    buffer_load_dwordx4 v17, s[24:27], s41 offen lds
    s_mov_b32 m0, 43008
    s_nop 0
    buffer_load_dwordx4 v18, s[24:27], s41 offen lds
    s_mov_b32 m0, 44032
    s_nop 0
    buffer_load_dwordx4 v19, s[24:27], s41 offen lds
    s_mov_b32 m0, 45056
    s_nop 0
    buffer_load_dwordx4 v20, s[24:27], s41 offen lds
    s_mov_b32 m0, 46080
    s_nop 0
    buffer_load_dwordx4 v21, s[24:27], s41 offen lds
    s_mov_b32 m0, 47104
    s_nop 0
    buffer_load_dwordx4 v22, s[24:27], s41 offen lds
    s_mov_b32 m0, 48128
    s_nop 0
    buffer_load_dwordx4 v23, s[24:27], s41 offen lds
    s_waitcnt vmcnt(48)
    s_barrier
    s_mov_b32 s41, 24576
    s_mov_b32 m0, 49152
    s_nop 0
    buffer_load_dwordx4 v8, s[20:23], s41 offen lds
    s_mov_b32 m0, 50176
    s_nop 0
    buffer_load_dwordx4 v9, s[20:23], s41 offen lds
    s_mov_b32 m0, 51200
    s_nop 0
    buffer_load_dwordx4 v10, s[20:23], s41 offen lds
    s_mov_b32 m0, 52224
    s_nop 0
    buffer_load_dwordx4 v11, s[20:23], s41 offen lds
    s_mov_b32 m0, 53248
    s_nop 0
    buffer_load_dwordx4 v12, s[20:23], s41 offen lds
    s_mov_b32 m0, 54272
    s_nop 0
    buffer_load_dwordx4 v13, s[20:23], s41 offen lds
    s_mov_b32 m0, 55296
    s_nop 0
    buffer_load_dwordx4 v14, s[20:23], s41 offen lds
    s_mov_b32 m0, 56320
    s_nop 0
    buffer_load_dwordx4 v15, s[20:23], s41 offen lds
    s_waitcnt vmcnt(48)
    s_barrier
    s_mov_b32 s41, 24576
    s_mov_b32 m0, 57344
    s_nop 0
    buffer_load_dwordx4 v16, s[24:27], s41 offen lds
    s_mov_b32 m0, 58368
    s_nop 0
    buffer_load_dwordx4 v17, s[24:27], s41 offen lds
    s_mov_b32 m0, 59392
    s_nop 0
    buffer_load_dwordx4 v18, s[24:27], s41 offen lds
    s_mov_b32 m0, 60416
    s_nop 0
    buffer_load_dwordx4 v19, s[24:27], s41 offen lds
    s_mov_b32 m0, 61440
    s_nop 0
    buffer_load_dwordx4 v20, s[24:27], s41 offen lds
    s_mov_b32 m0, 62464
    s_nop 0
    buffer_load_dwordx4 v21, s[24:27], s41 offen lds
    s_mov_b32 m0, 63488
    s_nop 0
    buffer_load_dwordx4 v22, s[24:27], s41 offen lds
    s_mov_b32 m0, 64512
    s_nop 0
    buffer_load_dwordx4 v23, s[24:27], s41 offen lds
    s_waitcnt vmcnt(48)
    s_barrier
    s_mov_b32 s41, 32768
    s_mov_b32 m0, 0
    s_nop 0
    buffer_load_dwordx4 v8, s[20:23], s41 offen lds
    s_mov_b32 m0, 1024
    s_nop 0
    buffer_load_dwordx4 v9, s[20:23], s41 offen lds
    s_mov_b32 m0, 2048
    s_nop 0
    buffer_load_dwordx4 v10, s[20:23], s41 offen lds
    s_mov_b32 m0, 3072
    s_nop 0
    buffer_load_dwordx4 v11, s[20:23], s41 offen lds
    s_mov_b32 m0, 4096
    s_nop 0
    buffer_load_dwordx4 v12, s[20:23], s41 offen lds
    s_mov_b32 m0, 5120
    s_nop 0
    buffer_load_dwordx4 v13, s[20:23], s41 offen lds
    s_mov_b32 m0, 6144
    s_nop 0
    buffer_load_dwordx4 v14, s[20:23], s41 offen lds
    s_mov_b32 m0, 7168
    s_nop 0
    buffer_load_dwordx4 v15, s[20:23], s41 offen lds
    s_waitcnt vmcnt(48)
    s_barrier
    s_mov_b32 s41, 32768
    s_mov_b32 m0, 8192
    s_nop 0
    buffer_load_dwordx4 v16, s[24:27], s41 offen lds
    s_mov_b32 m0, 9216
    s_nop 0
    buffer_load_dwordx4 v17, s[24:27], s41 offen lds
    s_mov_b32 m0, 10240
    s_nop 0
    buffer_load_dwordx4 v18, s[24:27], s41 offen lds
    s_mov_b32 m0, 11264
    s_nop 0
    buffer_load_dwordx4 v19, s[24:27], s41 offen lds
    s_mov_b32 m0, 12288
    s_nop 0
    buffer_load_dwordx4 v20, s[24:27], s41 offen lds
    s_mov_b32 m0, 13312
    s_nop 0
    buffer_load_dwordx4 v21, s[24:27], s41 offen lds
    s_mov_b32 m0, 14336
    s_nop 0
    buffer_load_dwordx4 v22, s[24:27], s41 offen lds
    s_mov_b32 m0, 15360
    s_nop 0
    buffer_load_dwordx4 v23, s[24:27], s41 offen lds
    s_waitcnt vmcnt(48)
    s_barrier
    s_mov_b32 s41, 40960
    s_mov_b32 m0, 16384
    s_nop 0
    buffer_load_dwordx4 v8, s[20:23], s41 offen lds
    s_mov_b32 m0, 17408
    s_nop 0
    buffer_load_dwordx4 v9, s[20:23], s41 offen lds
    s_mov_b32 m0, 18432
    s_nop 0
    buffer_load_dwordx4 v10, s[20:23], s41 offen lds
    s_mov_b32 m0, 19456
    s_nop 0
    buffer_load_dwordx4 v11, s[20:23], s41 offen lds
    s_mov_b32 m0, 20480
    s_nop 0
    buffer_load_dwordx4 v12, s[20:23], s41 offen lds
    s_mov_b32 m0, 21504
    s_nop 0
    buffer_load_dwordx4 v13, s[20:23], s41 offen lds
    s_mov_b32 m0, 22528
    s_nop 0
    buffer_load_dwordx4 v14, s[20:23], s41 offen lds
    s_mov_b32 m0, 23552
    s_nop 0
    buffer_load_dwordx4 v15, s[20:23], s41 offen lds
    s_waitcnt vmcnt(48)
    s_barrier
    s_mov_b32 s41, 40960
    s_mov_b32 m0, 24576
    s_nop 0
    buffer_load_dwordx4 v16, s[24:27], s41 offen lds
    s_mov_b32 m0, 25600
    s_nop 0
    buffer_load_dwordx4 v17, s[24:27], s41 offen lds
    s_mov_b32 m0, 26624
    s_nop 0
    buffer_load_dwordx4 v18, s[24:27], s41 offen lds
    s_mov_b32 m0, 27648
    s_nop 0
    buffer_load_dwordx4 v19, s[24:27], s41 offen lds
    s_mov_b32 m0, 28672
    s_nop 0
    buffer_load_dwordx4 v20, s[24:27], s41 offen lds
    s_mov_b32 m0, 29696
    s_nop 0
    buffer_load_dwordx4 v21, s[24:27], s41 offen lds
    s_mov_b32 m0, 30720
    s_nop 0
    buffer_load_dwordx4 v22, s[24:27], s41 offen lds
    s_mov_b32 m0, 31744
    s_nop 0
    buffer_load_dwordx4 v23, s[24:27], s41 offen lds
    s_waitcnt vmcnt(48)
    s_barrier
    s_mov_b32 s41, 49152
    s_mov_b32 m0, 32768
    s_nop 0
    buffer_load_dwordx4 v8, s[20:23], s41 offen lds
    s_mov_b32 m0, 33792
    s_nop 0
    buffer_load_dwordx4 v9, s[20:23], s41 offen lds
    s_mov_b32 m0, 34816
    s_nop 0
    buffer_load_dwordx4 v10, s[20:23], s41 offen lds
    s_mov_b32 m0, 35840
    s_nop 0
    buffer_load_dwordx4 v11, s[20:23], s41 offen lds
    s_mov_b32 m0, 36864
    s_nop 0
    buffer_load_dwordx4 v12, s[20:23], s41 offen lds
    s_mov_b32 m0, 37888
    s_nop 0
    buffer_load_dwordx4 v13, s[20:23], s41 offen lds
    s_mov_b32 m0, 38912
    s_nop 0
    buffer_load_dwordx4 v14, s[20:23], s41 offen lds
    s_mov_b32 m0, 39936
    s_nop 0
    buffer_load_dwordx4 v15, s[20:23], s41 offen lds
    s_waitcnt vmcnt(48)
    s_barrier
    s_mov_b32 s41, 49152
    s_mov_b32 m0, 40960
    s_nop 0
    buffer_load_dwordx4 v16, s[24:27], s41 offen lds
    s_mov_b32 m0, 41984
    s_nop 0
    buffer_load_dwordx4 v17, s[24:27], s41 offen lds
    s_mov_b32 m0, 43008
    s_nop 0
    buffer_load_dwordx4 v18, s[24:27], s41 offen lds
    s_mov_b32 m0, 44032
    s_nop 0
    buffer_load_dwordx4 v19, s[24:27], s41 offen lds
    s_mov_b32 m0, 45056
    s_nop 0
    buffer_load_dwordx4 v20, s[24:27], s41 offen lds
    s_mov_b32 m0, 46080
    s_nop 0
    buffer_load_dwordx4 v21, s[24:27], s41 offen lds
    s_mov_b32 m0, 47104
    s_nop 0
    buffer_load_dwordx4 v22, s[24:27], s41 offen lds
    s_mov_b32 m0, 48128
    s_nop 0
    buffer_load_dwordx4 v23, s[24:27], s41 offen lds
    s_waitcnt vmcnt(48)
    s_barrier
    s_mov_b32 s41, 57344
    s_mov_b32 m0, 49152
    s_nop 0
    buffer_load_dwordx4 v8, s[20:23], s41 offen lds
    s_mov_b32 m0, 50176
    s_nop 0
    buffer_load_dwordx4 v9, s[20:23], s41 offen lds
    s_mov_b32 m0, 51200
    s_nop 0
    buffer_load_dwordx4 v10, s[20:23], s41 offen lds
    s_mov_b32 m0, 52224
    s_nop 0
    buffer_load_dwordx4 v11, s[20:23], s41 offen lds
    s_mov_b32 m0, 53248
    s_nop 0
    buffer_load_dwordx4 v12, s[20:23], s41 offen lds
    s_mov_b32 m0, 54272
    s_nop 0
    buffer_load_dwordx4 v13, s[20:23], s41 offen lds
    s_mov_b32 m0, 55296
    s_nop 0
    buffer_load_dwordx4 v14, s[20:23], s41 offen lds
    s_mov_b32 m0, 56320
    s_nop 0
    buffer_load_dwordx4 v15, s[20:23], s41 offen lds
    s_waitcnt vmcnt(48)
    s_barrier
    s_mov_b32 s41, 57344
    s_mov_b32 m0, 57344
    s_nop 0
    buffer_load_dwordx4 v16, s[24:27], s41 offen lds
    s_mov_b32 m0, 58368
    s_nop 0
    buffer_load_dwordx4 v17, s[24:27], s41 offen lds
    s_mov_b32 m0, 59392
    s_nop 0
    buffer_load_dwordx4 v18, s[24:27], s41 offen lds
    s_mov_b32 m0, 60416
    s_nop 0
    buffer_load_dwordx4 v19, s[24:27], s41 offen lds
    s_mov_b32 m0, 61440
    s_nop 0
    buffer_load_dwordx4 v20, s[24:27], s41 offen lds
    s_mov_b32 m0, 62464
    s_nop 0
    buffer_load_dwordx4 v21, s[24:27], s41 offen lds
    s_mov_b32 m0, 63488
    s_nop 0
    buffer_load_dwordx4 v22, s[24:27], s41 offen lds
    s_mov_b32 m0, 64512
    s_nop 0
    buffer_load_dwordx4 v23, s[24:27], s41 offen lds
    s_waitcnt vmcnt(48)
    s_barrier
    s_mov_b32 s41, 65536
    s_mov_b32 m0, 0
    s_nop 0
    buffer_load_dwordx4 v8, s[20:23], s41 offen lds
    s_mov_b32 m0, 1024
    s_nop 0
    buffer_load_dwordx4 v9, s[20:23], s41 offen lds
    s_mov_b32 m0, 2048
    s_nop 0
    buffer_load_dwordx4 v10, s[20:23], s41 offen lds
    s_mov_b32 m0, 3072
    s_nop 0
    buffer_load_dwordx4 v11, s[20:23], s41 offen lds
    s_mov_b32 m0, 4096
    s_nop 0
    buffer_load_dwordx4 v12, s[20:23], s41 offen lds
    s_mov_b32 m0, 5120
    s_nop 0
    buffer_load_dwordx4 v13, s[20:23], s41 offen lds
    s_mov_b32 m0, 6144
    s_nop 0
    buffer_load_dwordx4 v14, s[20:23], s41 offen lds
    s_mov_b32 m0, 7168
    s_nop 0
    buffer_load_dwordx4 v15, s[20:23], s41 offen lds
    s_waitcnt vmcnt(48)
    s_barrier
    s_mov_b32 s41, 65536
    s_mov_b32 m0, 8192
    s_nop 0
    buffer_load_dwordx4 v16, s[24:27], s41 offen lds
    s_mov_b32 m0, 9216
    s_nop 0
    buffer_load_dwordx4 v17, s[24:27], s41 offen lds
    s_mov_b32 m0, 10240
    s_nop 0
    buffer_load_dwordx4 v18, s[24:27], s41 offen lds
    s_mov_b32 m0, 11264
    s_nop 0
    buffer_load_dwordx4 v19, s[24:27], s41 offen lds
    s_mov_b32 m0, 12288
    s_nop 0
    buffer_load_dwordx4 v20, s[24:27], s41 offen lds
    s_mov_b32 m0, 13312
    s_nop 0
    buffer_load_dwordx4 v21, s[24:27], s41 offen lds
    s_mov_b32 m0, 14336
    s_nop 0
    buffer_load_dwordx4 v22, s[24:27], s41 offen lds
    s_mov_b32 m0, 15360
    s_nop 0
    buffer_load_dwordx4 v23, s[24:27], s41 offen lds
    s_waitcnt vmcnt(48)
    s_barrier
    s_mov_b32 s41, 73728
    s_mov_b32 m0, 16384
    s_nop 0
    buffer_load_dwordx4 v8, s[20:23], s41 offen lds
    s_mov_b32 m0, 17408
    s_nop 0
    buffer_load_dwordx4 v9, s[20:23], s41 offen lds
    s_mov_b32 m0, 18432
    s_nop 0
    buffer_load_dwordx4 v10, s[20:23], s41 offen lds
    s_mov_b32 m0, 19456
    s_nop 0
    buffer_load_dwordx4 v11, s[20:23], s41 offen lds
    s_mov_b32 m0, 20480
    s_nop 0
    buffer_load_dwordx4 v12, s[20:23], s41 offen lds
    s_mov_b32 m0, 21504
    s_nop 0
    buffer_load_dwordx4 v13, s[20:23], s41 offen lds
    s_mov_b32 m0, 22528
    s_nop 0
    buffer_load_dwordx4 v14, s[20:23], s41 offen lds
    s_mov_b32 m0, 23552
    s_nop 0
    buffer_load_dwordx4 v15, s[20:23], s41 offen lds
    s_waitcnt vmcnt(48)
    s_barrier
    s_mov_b32 s41, 73728
    s_mov_b32 m0, 24576
    s_nop 0
    buffer_load_dwordx4 v16, s[24:27], s41 offen lds
    s_mov_b32 m0, 25600
    s_nop 0
    buffer_load_dwordx4 v17, s[24:27], s41 offen lds
    s_mov_b32 m0, 26624
    s_nop 0
    buffer_load_dwordx4 v18, s[24:27], s41 offen lds
    s_mov_b32 m0, 27648
    s_nop 0
    buffer_load_dwordx4 v19, s[24:27], s41 offen lds
    s_mov_b32 m0, 28672
    s_nop 0
    buffer_load_dwordx4 v20, s[24:27], s41 offen lds
    s_mov_b32 m0, 29696
    s_nop 0
    buffer_load_dwordx4 v21, s[24:27], s41 offen lds
    s_mov_b32 m0, 30720
    s_nop 0
    buffer_load_dwordx4 v22, s[24:27], s41 offen lds
    s_mov_b32 m0, 31744
    s_nop 0
    buffer_load_dwordx4 v23, s[24:27], s41 offen lds
    s_waitcnt vmcnt(48)
    s_barrier
    s_mov_b32 s41, 81920
    s_mov_b32 m0, 32768
    s_nop 0
    buffer_load_dwordx4 v8, s[20:23], s41 offen lds
    s_mov_b32 m0, 33792
    s_nop 0
    buffer_load_dwordx4 v9, s[20:23], s41 offen lds
    s_mov_b32 m0, 34816
    s_nop 0
    buffer_load_dwordx4 v10, s[20:23], s41 offen lds
    s_mov_b32 m0, 35840
    s_nop 0
    buffer_load_dwordx4 v11, s[20:23], s41 offen lds
    s_mov_b32 m0, 36864
    s_nop 0
    buffer_load_dwordx4 v12, s[20:23], s41 offen lds
    s_mov_b32 m0, 37888
    s_nop 0
    buffer_load_dwordx4 v13, s[20:23], s41 offen lds
    s_mov_b32 m0, 38912
    s_nop 0
    buffer_load_dwordx4 v14, s[20:23], s41 offen lds
    s_mov_b32 m0, 39936
    s_nop 0
    buffer_load_dwordx4 v15, s[20:23], s41 offen lds
    s_waitcnt vmcnt(48)
    s_barrier
    s_mov_b32 s41, 81920
    s_mov_b32 m0, 40960
    s_nop 0
    buffer_load_dwordx4 v16, s[24:27], s41 offen lds
    s_mov_b32 m0, 41984
    s_nop 0
    buffer_load_dwordx4 v17, s[24:27], s41 offen lds
    s_mov_b32 m0, 43008
    s_nop 0
    buffer_load_dwordx4 v18, s[24:27], s41 offen lds
    s_mov_b32 m0, 44032
    s_nop 0
    buffer_load_dwordx4 v19, s[24:27], s41 offen lds
    s_mov_b32 m0, 45056
    s_nop 0
    buffer_load_dwordx4 v20, s[24:27], s41 offen lds
    s_mov_b32 m0, 46080
    s_nop 0
    buffer_load_dwordx4 v21, s[24:27], s41 offen lds
    s_mov_b32 m0, 47104
    s_nop 0
    buffer_load_dwordx4 v22, s[24:27], s41 offen lds
    s_mov_b32 m0, 48128
    s_nop 0
    buffer_load_dwordx4 v23, s[24:27], s41 offen lds
    s_waitcnt vmcnt(48)
    s_barrier
    s_mov_b32 s41, 90112
    s_mov_b32 m0, 49152
    s_nop 0
    buffer_load_dwordx4 v8, s[20:23], s41 offen lds
    s_mov_b32 m0, 50176
    s_nop 0
    buffer_load_dwordx4 v9, s[20:23], s41 offen lds
    s_mov_b32 m0, 51200
    s_nop 0
    buffer_load_dwordx4 v10, s[20:23], s41 offen lds
    s_mov_b32 m0, 52224
    s_nop 0
    buffer_load_dwordx4 v11, s[20:23], s41 offen lds
    s_mov_b32 m0, 53248
    s_nop 0
    buffer_load_dwordx4 v12, s[20:23], s41 offen lds
    s_mov_b32 m0, 54272
    s_nop 0
    buffer_load_dwordx4 v13, s[20:23], s41 offen lds
    s_mov_b32 m0, 55296
    s_nop 0
    buffer_load_dwordx4 v14, s[20:23], s41 offen lds
    s_mov_b32 m0, 56320
    s_nop 0
    buffer_load_dwordx4 v15, s[20:23], s41 offen lds
    s_waitcnt vmcnt(48)
    s_barrier
    s_mov_b32 s41, 90112
    s_mov_b32 m0, 57344
    s_nop 0
    buffer_load_dwordx4 v16, s[24:27], s41 offen lds
    s_mov_b32 m0, 58368
    s_nop 0
    buffer_load_dwordx4 v17, s[24:27], s41 offen lds
    s_mov_b32 m0, 59392
    s_nop 0
    buffer_load_dwordx4 v18, s[24:27], s41 offen lds
    s_mov_b32 m0, 60416
    s_nop 0
    buffer_load_dwordx4 v19, s[24:27], s41 offen lds
    s_mov_b32 m0, 61440
    s_nop 0
    buffer_load_dwordx4 v20, s[24:27], s41 offen lds
    s_mov_b32 m0, 62464
    s_nop 0
    buffer_load_dwordx4 v21, s[24:27], s41 offen lds
    s_mov_b32 m0, 63488
    s_nop 0
    buffer_load_dwordx4 v22, s[24:27], s41 offen lds
    s_mov_b32 m0, 64512
    s_nop 0
    buffer_load_dwordx4 v23, s[24:27], s41 offen lds
    s_waitcnt vmcnt(48)
    s_barrier
    s_mov_b32 s41, 98304
    s_mov_b32 m0, 0
    s_nop 0
    buffer_load_dwordx4 v8, s[20:23], s41 offen lds
    s_mov_b32 m0, 1024
    s_nop 0
    buffer_load_dwordx4 v9, s[20:23], s41 offen lds
    s_mov_b32 m0, 2048
    s_nop 0
    buffer_load_dwordx4 v10, s[20:23], s41 offen lds
    s_mov_b32 m0, 3072
    s_nop 0
    buffer_load_dwordx4 v11, s[20:23], s41 offen lds
    s_mov_b32 m0, 4096
    s_nop 0
    buffer_load_dwordx4 v12, s[20:23], s41 offen lds
    s_mov_b32 m0, 5120
    s_nop 0
    buffer_load_dwordx4 v13, s[20:23], s41 offen lds
    s_mov_b32 m0, 6144
    s_nop 0
    buffer_load_dwordx4 v14, s[20:23], s41 offen lds
    s_mov_b32 m0, 7168
    s_nop 0
    buffer_load_dwordx4 v15, s[20:23], s41 offen lds
    s_waitcnt vmcnt(48)
    s_barrier
    s_mov_b32 s41, 98304
    s_mov_b32 m0, 8192
    s_nop 0
    buffer_load_dwordx4 v16, s[24:27], s41 offen lds
    s_mov_b32 m0, 9216
    s_nop 0
    buffer_load_dwordx4 v17, s[24:27], s41 offen lds
    s_mov_b32 m0, 10240
    s_nop 0
    buffer_load_dwordx4 v18, s[24:27], s41 offen lds
    s_mov_b32 m0, 11264
    s_nop 0
    buffer_load_dwordx4 v19, s[24:27], s41 offen lds
    s_mov_b32 m0, 12288
    s_nop 0
    buffer_load_dwordx4 v20, s[24:27], s41 offen lds
    s_mov_b32 m0, 13312
    s_nop 0
    buffer_load_dwordx4 v21, s[24:27], s41 offen lds
    s_mov_b32 m0, 14336
    s_nop 0
    buffer_load_dwordx4 v22, s[24:27], s41 offen lds
    s_mov_b32 m0, 15360
    s_nop 0
    buffer_load_dwordx4 v23, s[24:27], s41 offen lds
    s_waitcnt vmcnt(48)
    s_barrier
    s_mov_b32 s41, 106496
    s_mov_b32 m0, 16384
    s_nop 0
    buffer_load_dwordx4 v8, s[20:23], s41 offen lds
    s_mov_b32 m0, 17408
    s_nop 0
    buffer_load_dwordx4 v9, s[20:23], s41 offen lds
    s_mov_b32 m0, 18432
    s_nop 0
    buffer_load_dwordx4 v10, s[20:23], s41 offen lds
    s_mov_b32 m0, 19456
    s_nop 0
    buffer_load_dwordx4 v11, s[20:23], s41 offen lds
    s_mov_b32 m0, 20480
    s_nop 0
    buffer_load_dwordx4 v12, s[20:23], s41 offen lds
    s_mov_b32 m0, 21504
    s_nop 0
    buffer_load_dwordx4 v13, s[20:23], s41 offen lds
    s_mov_b32 m0, 22528
    s_nop 0
    buffer_load_dwordx4 v14, s[20:23], s41 offen lds
    s_mov_b32 m0, 23552
    s_nop 0
    buffer_load_dwordx4 v15, s[20:23], s41 offen lds
    s_waitcnt vmcnt(48)
    s_barrier
    s_mov_b32 s41, 106496
    s_mov_b32 m0, 24576
    s_nop 0
    buffer_load_dwordx4 v16, s[24:27], s41 offen lds
    s_mov_b32 m0, 25600
    s_nop 0
    buffer_load_dwordx4 v17, s[24:27], s41 offen lds
    s_mov_b32 m0, 26624
    s_nop 0
    buffer_load_dwordx4 v18, s[24:27], s41 offen lds
    s_mov_b32 m0, 27648
    s_nop 0
    buffer_load_dwordx4 v19, s[24:27], s41 offen lds
    s_mov_b32 m0, 28672
    s_nop 0
    buffer_load_dwordx4 v20, s[24:27], s41 offen lds
    s_mov_b32 m0, 29696
    s_nop 0
    buffer_load_dwordx4 v21, s[24:27], s41 offen lds
    s_mov_b32 m0, 30720
    s_nop 0
    buffer_load_dwordx4 v22, s[24:27], s41 offen lds
    s_mov_b32 m0, 31744
    s_nop 0
    buffer_load_dwordx4 v23, s[24:27], s41 offen lds
    s_waitcnt vmcnt(48)
    s_barrier
    s_mov_b32 s41, 114688
    s_mov_b32 m0, 32768
    s_nop 0
    buffer_load_dwordx4 v8, s[20:23], s41 offen lds
    s_mov_b32 m0, 33792
    s_nop 0
    buffer_load_dwordx4 v9, s[20:23], s41 offen lds
    s_mov_b32 m0, 34816
    s_nop 0
    buffer_load_dwordx4 v10, s[20:23], s41 offen lds
    s_mov_b32 m0, 35840
    s_nop 0
    buffer_load_dwordx4 v11, s[20:23], s41 offen lds
    s_mov_b32 m0, 36864
    s_nop 0
    buffer_load_dwordx4 v12, s[20:23], s41 offen lds
    s_mov_b32 m0, 37888
    s_nop 0
    buffer_load_dwordx4 v13, s[20:23], s41 offen lds
    s_mov_b32 m0, 38912
    s_nop 0
    buffer_load_dwordx4 v14, s[20:23], s41 offen lds
    s_mov_b32 m0, 39936
    s_nop 0
    buffer_load_dwordx4 v15, s[20:23], s41 offen lds
    s_waitcnt vmcnt(48)
    s_barrier
    s_mov_b32 s41, 114688
    s_mov_b32 m0, 40960
    s_nop 0
    buffer_load_dwordx4 v16, s[24:27], s41 offen lds
    s_mov_b32 m0, 41984
    s_nop 0
    buffer_load_dwordx4 v17, s[24:27], s41 offen lds
    s_mov_b32 m0, 43008
    s_nop 0
    buffer_load_dwordx4 v18, s[24:27], s41 offen lds
    s_mov_b32 m0, 44032
    s_nop 0
    buffer_load_dwordx4 v19, s[24:27], s41 offen lds
    s_mov_b32 m0, 45056
    s_nop 0
    buffer_load_dwordx4 v20, s[24:27], s41 offen lds
    s_mov_b32 m0, 46080
    s_nop 0
    buffer_load_dwordx4 v21, s[24:27], s41 offen lds
    s_mov_b32 m0, 47104
    s_nop 0
    buffer_load_dwordx4 v22, s[24:27], s41 offen lds
    s_mov_b32 m0, 48128
    s_nop 0
    buffer_load_dwordx4 v23, s[24:27], s41 offen lds
    s_waitcnt vmcnt(48)
    s_barrier
    s_mov_b32 s41, 122880
    s_mov_b32 m0, 49152
    s_nop 0
    buffer_load_dwordx4 v8, s[20:23], s41 offen lds
    s_mov_b32 m0, 50176
    s_nop 0
    buffer_load_dwordx4 v9, s[20:23], s41 offen lds
    s_mov_b32 m0, 51200
    s_nop 0
    buffer_load_dwordx4 v10, s[20:23], s41 offen lds
    s_mov_b32 m0, 52224
    s_nop 0
    buffer_load_dwordx4 v11, s[20:23], s41 offen lds
    s_mov_b32 m0, 53248
    s_nop 0
    buffer_load_dwordx4 v12, s[20:23], s41 offen lds
    s_mov_b32 m0, 54272
    s_nop 0
    buffer_load_dwordx4 v13, s[20:23], s41 offen lds
    s_mov_b32 m0, 55296
    s_nop 0
    buffer_load_dwordx4 v14, s[20:23], s41 offen lds
    s_mov_b32 m0, 56320
    s_nop 0
    buffer_load_dwordx4 v15, s[20:23], s41 offen lds
    s_waitcnt vmcnt(48)
    s_barrier
    s_mov_b32 s41, 122880
    s_mov_b32 m0, 57344
    s_nop 0
    buffer_load_dwordx4 v16, s[24:27], s41 offen lds
    s_mov_b32 m0, 58368
    s_nop 0
    buffer_load_dwordx4 v17, s[24:27], s41 offen lds
    s_mov_b32 m0, 59392
    s_nop 0
    buffer_load_dwordx4 v18, s[24:27], s41 offen lds
    s_mov_b32 m0, 60416
    s_nop 0
    buffer_load_dwordx4 v19, s[24:27], s41 offen lds
    s_mov_b32 m0, 61440
    s_nop 0
    buffer_load_dwordx4 v20, s[24:27], s41 offen lds
    s_mov_b32 m0, 62464
    s_nop 0
    buffer_load_dwordx4 v21, s[24:27], s41 offen lds
    s_mov_b32 m0, 63488
    s_nop 0
    buffer_load_dwordx4 v22, s[24:27], s41 offen lds
    s_mov_b32 m0, 64512
    s_nop 0
    buffer_load_dwordx4 v23, s[24:27], s41 offen lds
    s_waitcnt vmcnt(48)
    s_barrier
    s_waitcnt vmcnt(40)
    s_barrier
    s_waitcnt vmcnt(32)
    s_barrier
    s_waitcnt vmcnt(24)
    s_barrier
    s_waitcnt vmcnt(16)
    s_barrier
    s_waitcnt vmcnt(8)
    s_barrier
    s_waitcnt vmcnt(0)
    s_barrier
    s_branch A_end
A_end:
    s_endpgm
.globl oproj_kernel
.p2align 8
.type oproj_kernel,@function
oproj_kernel:
    s_cmp_ge_u32 s2, 256
    s_cbranch_scc1 B_end
    v_and_b32 v200, 63, v0
    v_lshrrev_b32 v1, 6, v0
    s_nop 0
    v_readfirstlane_b32 s40, v1
    s_lshr_b32 s3, s2, 7
    s_bfe_u32 s4, s2, 0x30004
    s_bfe_u32 s5, s2, 0x20002
    s_and_b32 s45, s2, 3
    s_mul_i32 s6, s3, 40
    s_add_u32 s6, s0, s6
    s_addc_u32 s7, s1, 0
    s_load_dwordx2 s[8:9], s[6:7], 32
    s_load_dwordx2 s[16:17], s[0:1], 96
    s_waitcnt lgkmcnt(0)
    s_lshl_b32 s41, s45, 20
    s_lshl_b32 s42, s5, 8
    s_add_u32 s41, s41, s42
    s_add_u32 s28, s8, s41
    s_addc_u32 s29, s9, 0
    s_and_b32 s29, s29, 0xffff
    s_sub_u32 s30, 4194304, s41
    s_mov_b32 s31, 0x20000
    s_mov_b32 s32, s16
    s_and_b32 s33, s17, 0xffff
    s_mov_b32 s34, 12582912
    s_mov_b32 s35, 0x20000
    s_add_u32 s36, s16, 16777216
    s_addc_u32 s37, s17, 0
    s_and_b32 s37, s37, 0xffff
    s_mov_b32 s38, 25165824
    s_mov_b32 s39, 0x20000
    s_cmp_eq_u32 s40, 3
    s_cbranch_scc1 B_prod
    v_and_b32 v1, 31, v200
    v_lshrrev_b32 v2, 5, v200
    v_bfe_u32 v3, v200, 2, 2
    v_and_b32 v4, 3, v200
    v_bfe_u32 v5, v200, 4, 1
    v_and_b32 v8, 1, v4
    v_lshl_add_u32 v8, v5, 1, v8
    v_lshlrev_b32 v8, 4, v8
    v_lshrrev_b32 v9, 1, v4
    v_lshl_add_u32 v8, v9, 3, v8
    v_xor_b32 v9, 0, v3
    v_lshl_add_u32 v9, v9, 6, v8
    v_lshl_add_u32 v10, v2, 2, v3
    v_lshl_add_u32 v184, v10, 8, v9
    v_lshl_add_u32 v10, v2, 3, v3
    v_lshl_add_u32 v188, v10, 8, v9
    v_xor_b32 v9, 1, v3
    v_lshl_add_u32 v9, v9, 6, v8
    v_lshl_add_u32 v10, v2, 2, v3
    v_lshl_add_u32 v185, v10, 8, v9
    v_lshl_add_u32 v10, v2, 3, v3
    v_lshl_add_u32 v189, v10, 8, v9
    v_xor_b32 v9, 2, v3
    v_lshl_add_u32 v9, v9, 6, v8
    v_lshl_add_u32 v10, v2, 2, v3
    v_lshl_add_u32 v186, v10, 8, v9
    v_lshl_add_u32 v10, v2, 3, v3
    v_lshl_add_u32 v190, v10, 8, v9
    v_xor_b32 v9, 3, v3
    v_lshl_add_u32 v9, v9, 6, v8
    v_lshl_add_u32 v10, v2, 2, v3
    v_lshl_add_u32 v187, v10, 8, v9
    v_lshl_add_u32 v10, v2, 3, v3
    v_lshl_add_u32 v191, v10, 8, v9
    s_lshl_b32 s41, s40, 5
    s_mul_i32 s42, s3, 768
    s_mul_i32 s43, s4, 96
    s_add_u32 s42, s42, s43
    s_add_u32 s42, s42, s41
    v_add_u32 v8, s42, v1
    v_lshlrev_b32 v9, 13, v8
    s_lshl_b32 s43, s45, 11
    v_add_u32 v9, s43, v9
    v_lshl_add_u32 v192, v2, 4, v9
    v_lshlrev_b32 v9, 11, v8
    s_mul_i32 s43, s45, 3145728
    s_lshl_b32 s42, s5, 9
    s_add_u32 s43, s43, s42
    v_add_u32 v9, s43, v9
    v_lshl_add_u32 v199, v2, 5, v9
    buffer_load_dwordx4 v[152:155], v192, s[32:35], 0 offen offset:0
    buffer_load_dwordx4 v[156:159], v192, s[32:35], 0 offen offset:32
    buffer_load_dwordx4 v[160:163], v192, s[32:35], 0 offen offset:64
    buffer_load_dwordx4 v[164:167], v192, s[32:35], 0 offen offset:96
    buffer_load_dwordx4 v[168:171], v192, s[32:35], 0 offen offset:128
    buffer_load_dwordx4 v[172:175], v192, s[32:35], 0 offen offset:160
    s_barrier
    ds_read_b64_tr_b16 v[120:121], v188 offset:0
    ds_read_b64_tr_b16 v[122:123], v188 offset:1024
    ds_read_b64_tr_b16 v[124:125], v189 offset:0
    ds_read_b64_tr_b16 v[126:127], v189 offset:1024
    ds_read_b64_tr_b16 v[128:129], v190 offset:0
    ds_read_b64_tr_b16 v[130:131], v190 offset:1024
    ds_read_b64_tr_b16 v[132:133], v191 offset:0
    ds_read_b64_tr_b16 v[134:135], v191 offset:1024
    ds_read_b64_tr_b16 v[136:137], v188 offset:4096
    ds_read_b64_tr_b16 v[138:139], v188 offset:5120
    ds_read_b64_tr_b16 v[140:141], v189 offset:4096
    ds_read_b64_tr_b16 v[142:143], v189 offset:5120
    ds_read_b64_tr_b16 v[144:145], v190 offset:4096
    ds_read_b64_tr_b16 v[146:147], v190 offset:5120
    ds_read_b64_tr_b16 v[148:149], v191 offset:4096
    ds_read_b64_tr_b16 v[150:151], v191 offset:5120
    s_waitcnt vmcnt(4) lgkmcnt(0)
    v_mfma_f32_32x32x16_bf16 v[32:47], v[120:123], v[152:155], 0
    v_mfma_f32_32x32x16_bf16 v[48:63], v[124:127], v[152:155], 0
    v_mfma_f32_32x32x16_bf16 v[64:79], v[128:131], v[152:155], 0
    v_mfma_f32_32x32x16_bf16 v[80:95], v[132:135], v[152:155], 0
    v_mfma_f32_32x32x16_bf16 v[32:47], v[136:139], v[156:159], v[32:47]
    v_mfma_f32_32x32x16_bf16 v[48:63], v[140:143], v[156:159], v[48:63]
    v_mfma_f32_32x32x16_bf16 v[64:79], v[144:147], v[156:159], v[64:79]
    v_mfma_f32_32x32x16_bf16 v[80:95], v[148:151], v[156:159], v[80:95]
    buffer_load_dwordx4 v[152:155], v192, s[32:35], 0 offen offset:192
    buffer_load_dwordx4 v[156:159], v192, s[32:35], 0 offen offset:224
    s_barrier
    ds_read_b64_tr_b16 v[120:121], v188 offset:8192
    ds_read_b64_tr_b16 v[122:123], v188 offset:9216
    ds_read_b64_tr_b16 v[124:125], v189 offset:8192
    ds_read_b64_tr_b16 v[126:127], v189 offset:9216
    ds_read_b64_tr_b16 v[128:129], v190 offset:8192
    ds_read_b64_tr_b16 v[130:131], v190 offset:9216
    ds_read_b64_tr_b16 v[132:133], v191 offset:8192
    ds_read_b64_tr_b16 v[134:135], v191 offset:9216
    ds_read_b64_tr_b16 v[136:137], v188 offset:12288
    ds_read_b64_tr_b16 v[138:139], v188 offset:13312
    ds_read_b64_tr_b16 v[140:141], v189 offset:12288
    ds_read_b64_tr_b16 v[142:143], v189 offset:13312
    ds_read_b64_tr_b16 v[144:145], v190 offset:12288
    ds_read_b64_tr_b16 v[146:147], v190 offset:13312
    ds_read_b64_tr_b16 v[148:149], v191 offset:12288
    ds_read_b64_tr_b16 v[150:151], v191 offset:13312
    s_waitcnt vmcnt(4) lgkmcnt(0)
    v_mfma_f32_32x32x16_bf16 v[32:47], v[120:123], v[160:163], v[32:47]
    v_mfma_f32_32x32x16_bf16 v[48:63], v[124:127], v[160:163], v[48:63]
    v_mfma_f32_32x32x16_bf16 v[64:79], v[128:131], v[160:163], v[64:79]
    v_mfma_f32_32x32x16_bf16 v[80:95], v[132:135], v[160:163], v[80:95]
    v_mfma_f32_32x32x16_bf16 v[32:47], v[136:139], v[164:167], v[32:47]
    v_mfma_f32_32x32x16_bf16 v[48:63], v[140:143], v[164:167], v[48:63]
    v_mfma_f32_32x32x16_bf16 v[64:79], v[144:147], v[164:167], v[64:79]
    v_mfma_f32_32x32x16_bf16 v[80:95], v[148:151], v[164:167], v[80:95]
    buffer_load_dwordx4 v[160:163], v192, s[32:35], 0 offen offset:256
    buffer_load_dwordx4 v[164:167], v192, s[32:35], 0 offen offset:288
    s_barrier
    ds_read_b64_tr_b16 v[120:121], v188 offset:16384
    ds_read_b64_tr_b16 v[122:123], v188 offset:17408
    ds_read_b64_tr_b16 v[124:125], v189 offset:16384
    ds_read_b64_tr_b16 v[126:127], v189 offset:17408
    ds_read_b64_tr_b16 v[128:129], v190 offset:16384
    ds_read_b64_tr_b16 v[130:131], v190 offset:17408
    ds_read_b64_tr_b16 v[132:133], v191 offset:16384
    ds_read_b64_tr_b16 v[134:135], v191 offset:17408
    ds_read_b64_tr_b16 v[136:137], v188 offset:20480
    ds_read_b64_tr_b16 v[138:139], v188 offset:21504
    ds_read_b64_tr_b16 v[140:141], v189 offset:20480
    ds_read_b64_tr_b16 v[142:143], v189 offset:21504
    ds_read_b64_tr_b16 v[144:145], v190 offset:20480
    ds_read_b64_tr_b16 v[146:147], v190 offset:21504
    ds_read_b64_tr_b16 v[148:149], v191 offset:20480
    ds_read_b64_tr_b16 v[150:151], v191 offset:21504
    s_waitcnt vmcnt(4) lgkmcnt(0)
    v_mfma_f32_32x32x16_bf16 v[32:47], v[120:123], v[168:171], v[32:47]
    v_mfma_f32_32x32x16_bf16 v[48:63], v[124:127], v[168:171], v[48:63]
    v_mfma_f32_32x32x16_bf16 v[64:79], v[128:131], v[168:171], v[64:79]
    v_mfma_f32_32x32x16_bf16 v[80:95], v[132:135], v[168:171], v[80:95]
    v_mfma_f32_32x32x16_bf16 v[32:47], v[136:139], v[172:175], v[32:47]
    v_mfma_f32_32x32x16_bf16 v[48:63], v[140:143], v[172:175], v[48:63]
    v_mfma_f32_32x32x16_bf16 v[64:79], v[144:147], v[172:175], v[64:79]
    v_mfma_f32_32x32x16_bf16 v[80:95], v[148:151], v[172:175], v[80:95]
    buffer_load_dwordx4 v[168:171], v192, s[32:35], 0 offen offset:320
    buffer_load_dwordx4 v[172:175], v192, s[32:35], 0 offen offset:352
    s_barrier
    ds_read_b64_tr_b16 v[120:121], v188 offset:24576
    ds_read_b64_tr_b16 v[122:123], v188 offset:25600
    ds_read_b64_tr_b16 v[124:125], v189 offset:24576
    ds_read_b64_tr_b16 v[126:127], v189 offset:25600
    ds_read_b64_tr_b16 v[128:129], v190 offset:24576
    ds_read_b64_tr_b16 v[130:131], v190 offset:25600
    ds_read_b64_tr_b16 v[132:133], v191 offset:24576
    ds_read_b64_tr_b16 v[134:135], v191 offset:25600
    ds_read_b64_tr_b16 v[136:137], v188 offset:28672
    ds_read_b64_tr_b16 v[138:139], v188 offset:29696
    ds_read_b64_tr_b16 v[140:141], v189 offset:28672
    ds_read_b64_tr_b16 v[142:143], v189 offset:29696
    ds_read_b64_tr_b16 v[144:145], v190 offset:28672
    ds_read_b64_tr_b16 v[146:147], v190 offset:29696
    ds_read_b64_tr_b16 v[148:149], v191 offset:28672
    ds_read_b64_tr_b16 v[150:151], v191 offset:29696
    s_waitcnt vmcnt(4) lgkmcnt(0)
    v_mfma_f32_32x32x16_bf16 v[32:47], v[120:123], v[152:155], v[32:47]
    v_mfma_f32_32x32x16_bf16 v[48:63], v[124:127], v[152:155], v[48:63]
    v_mfma_f32_32x32x16_bf16 v[64:79], v[128:131], v[152:155], v[64:79]
    v_mfma_f32_32x32x16_bf16 v[80:95], v[132:135], v[152:155], v[80:95]
    v_mfma_f32_32x32x16_bf16 v[32:47], v[136:139], v[156:159], v[32:47]
    v_mfma_f32_32x32x16_bf16 v[48:63], v[140:143], v[156:159], v[48:63]
    v_mfma_f32_32x32x16_bf16 v[64:79], v[144:147], v[156:159], v[64:79]
    v_mfma_f32_32x32x16_bf16 v[80:95], v[148:151], v[156:159], v[80:95]
    buffer_load_dwordx4 v[152:155], v192, s[32:35], 0 offen offset:384
    buffer_load_dwordx4 v[156:159], v192, s[32:35], 0 offen offset:416
    s_barrier
    ds_read_b64_tr_b16 v[120:121], v188 offset:32768
    ds_read_b64_tr_b16 v[122:123], v188 offset:33792
    ds_read_b64_tr_b16 v[124:125], v189 offset:32768
    ds_read_b64_tr_b16 v[126:127], v189 offset:33792
    ds_read_b64_tr_b16 v[128:129], v190 offset:32768
    ds_read_b64_tr_b16 v[130:131], v190 offset:33792
    ds_read_b64_tr_b16 v[132:133], v191 offset:32768
    ds_read_b64_tr_b16 v[134:135], v191 offset:33792
    ds_read_b64_tr_b16 v[136:137], v188 offset:36864
    ds_read_b64_tr_b16 v[138:139], v188 offset:37888
    ds_read_b64_tr_b16 v[140:141], v189 offset:36864
    ds_read_b64_tr_b16 v[142:143], v189 offset:37888
    ds_read_b64_tr_b16 v[144:145], v190 offset:36864
    ds_read_b64_tr_b16 v[146:147], v190 offset:37888
    ds_read_b64_tr_b16 v[148:149], v191 offset:36864
    ds_read_b64_tr_b16 v[150:151], v191 offset:37888
    s_waitcnt vmcnt(4) lgkmcnt(0)
    v_mfma_f32_32x32x16_bf16 v[32:47], v[120:123], v[160:163], v[32:47]
    v_mfma_f32_32x32x16_bf16 v[48:63], v[124:127], v[160:163], v[48:63]
    v_mfma_f32_32x32x16_bf16 v[64:79], v[128:131], v[160:163], v[64:79]
    v_mfma_f32_32x32x16_bf16 v[80:95], v[132:135], v[160:163], v[80:95]
    v_mfma_f32_32x32x16_bf16 v[32:47], v[136:139], v[164:167], v[32:47]
    v_mfma_f32_32x32x16_bf16 v[48:63], v[140:143], v[164:167], v[48:63]
    v_mfma_f32_32x32x16_bf16 v[64:79], v[144:147], v[164:167], v[64:79]
    v_mfma_f32_32x32x16_bf16 v[80:95], v[148:151], v[164:167], v[80:95]
    buffer_load_dwordx4 v[160:163], v192, s[32:35], 0 offen offset:448
    buffer_load_dwordx4 v[164:167], v192, s[32:35], 0 offen offset:480
    s_barrier
    ds_read_b64_tr_b16 v[120:121], v188 offset:40960
    ds_read_b64_tr_b16 v[122:123], v188 offset:41984
    ds_read_b64_tr_b16 v[124:125], v189 offset:40960
    ds_read_b64_tr_b16 v[126:127], v189 offset:41984
    ds_read_b64_tr_b16 v[128:129], v190 offset:40960
    ds_read_b64_tr_b16 v[130:131], v190 offset:41984
    ds_read_b64_tr_b16 v[132:133], v191 offset:40960
    ds_read_b64_tr_b16 v[134:135], v191 offset:41984
    ds_read_b64_tr_b16 v[136:137], v188 offset:45056
    ds_read_b64_tr_b16 v[138:139], v188 offset:46080
    ds_read_b64_tr_b16 v[140:141], v189 offset:45056
    ds_read_b64_tr_b16 v[142:143], v189 offset:46080
    ds_read_b64_tr_b16 v[144:145], v190 offset:45056
    ds_read_b64_tr_b16 v[146:147], v190 offset:46080
    ds_read_b64_tr_b16 v[148:149], v191 offset:45056
    ds_read_b64_tr_b16 v[150:151], v191 offset:46080
    s_waitcnt vmcnt(4) lgkmcnt(0)
    v_mfma_f32_32x32x16_bf16 v[32:47], v[120:123], v[168:171], v[32:47]
    v_mfma_f32_32x32x16_bf16 v[48:63], v[124:127], v[168:171], v[48:63]
    v_mfma_f32_32x32x16_bf16 v[64:79], v[128:131], v[168:171], v[64:79]
    v_mfma_f32_32x32x16_bf16 v[80:95], v[132:135], v[168:171], v[80:95]
    v_mfma_f32_32x32x16_bf16 v[32:47], v[136:139], v[172:175], v[32:47]
    v_mfma_f32_32x32x16_bf16 v[48:63], v[140:143], v[172:175], v[48:63]
    v_mfma_f32_32x32x16_bf16 v[64:79], v[144:147], v[172:175], v[64:79]
    v_mfma_f32_32x32x16_bf16 v[80:95], v[148:151], v[172:175], v[80:95]
    buffer_load_dwordx4 v[168:171], v192, s[32:35], 0 offen offset:512
    buffer_load_dwordx4 v[172:175], v192, s[32:35], 0 offen offset:544
    s_barrier
    ds_read_b64_tr_b16 v[120:121], v188 offset:49152
    ds_read_b64_tr_b16 v[122:123], v188 offset:50176
    ds_read_b64_tr_b16 v[124:125], v189 offset:49152
    ds_read_b64_tr_b16 v[126:127], v189 offset:50176
    ds_read_b64_tr_b16 v[128:129], v190 offset:49152
    ds_read_b64_tr_b16 v[130:131], v190 offset:50176
    ds_read_b64_tr_b16 v[132:133], v191 offset:49152
    ds_read_b64_tr_b16 v[134:135], v191 offset:50176
    ds_read_b64_tr_b16 v[136:137], v188 offset:53248
    ds_read_b64_tr_b16 v[138:139], v188 offset:54272
    ds_read_b64_tr_b16 v[140:141], v189 offset:53248
    ds_read_b64_tr_b16 v[142:143], v189 offset:54272
    ds_read_b64_tr_b16 v[144:145], v190 offset:53248
    ds_read_b64_tr_b16 v[146:147], v190 offset:54272
    ds_read_b64_tr_b16 v[148:149], v191 offset:53248
    ds_read_b64_tr_b16 v[150:151], v191 offset:54272
    s_waitcnt vmcnt(4) lgkmcnt(0)
    v_mfma_f32_32x32x16_bf16 v[32:47], v[120:123], v[152:155], v[32:47]
    v_mfma_f32_32x32x16_bf16 v[48:63], v[124:127], v[152:155], v[48:63]
    v_mfma_f32_32x32x16_bf16 v[64:79], v[128:131], v[152:155], v[64:79]
    v_mfma_f32_32x32x16_bf16 v[80:95], v[132:135], v[152:155], v[80:95]
    v_mfma_f32_32x32x16_bf16 v[32:47], v[136:139], v[156:159], v[32:47]
    v_mfma_f32_32x32x16_bf16 v[48:63], v[140:143], v[156:159], v[48:63]
    v_mfma_f32_32x32x16_bf16 v[64:79], v[144:147], v[156:159], v[64:79]
    v_mfma_f32_32x32x16_bf16 v[80:95], v[148:151], v[156:159], v[80:95]
    buffer_load_dwordx4 v[152:155], v192, s[32:35], 0 offen offset:576
    buffer_load_dwordx4 v[156:159], v192, s[32:35], 0 offen offset:608
    s_barrier
    ds_read_b64_tr_b16 v[120:121], v188 offset:57344
    ds_read_b64_tr_b16 v[122:123], v188 offset:58368
    ds_read_b64_tr_b16 v[124:125], v189 offset:57344
    ds_read_b64_tr_b16 v[126:127], v189 offset:58368
    ds_read_b64_tr_b16 v[128:129], v190 offset:57344
    ds_read_b64_tr_b16 v[130:131], v190 offset:58368
    ds_read_b64_tr_b16 v[132:133], v191 offset:57344
    ds_read_b64_tr_b16 v[134:135], v191 offset:58368
    ds_read_b64_tr_b16 v[136:137], v188 offset:61440
    ds_read_b64_tr_b16 v[138:139], v188 offset:62464
    ds_read_b64_tr_b16 v[140:141], v189 offset:61440
    ds_read_b64_tr_b16 v[142:143], v189 offset:62464
    ds_read_b64_tr_b16 v[144:145], v190 offset:61440
    ds_read_b64_tr_b16 v[146:147], v190 offset:62464
    ds_read_b64_tr_b16 v[148:149], v191 offset:61440
    ds_read_b64_tr_b16 v[150:151], v191 offset:62464
    s_waitcnt vmcnt(4) lgkmcnt(0)
    v_mfma_f32_32x32x16_bf16 v[32:47], v[120:123], v[160:163], v[32:47]
    v_mfma_f32_32x32x16_bf16 v[48:63], v[124:127], v[160:163], v[48:63]
    v_mfma_f32_32x32x16_bf16 v[64:79], v[128:131], v[160:163], v[64:79]
    v_mfma_f32_32x32x16_bf16 v[80:95], v[132:135], v[160:163], v[80:95]
    v_mfma_f32_32x32x16_bf16 v[32:47], v[136:139], v[164:167], v[32:47]
    v_mfma_f32_32x32x16_bf16 v[48:63], v[140:143], v[164:167], v[48:63]
    v_mfma_f32_32x32x16_bf16 v[64:79], v[144:147], v[164:167], v[64:79]
    v_mfma_f32_32x32x16_bf16 v[80:95], v[148:151], v[164:167], v[80:95]
    buffer_load_dwordx4 v[160:163], v192, s[32:35], 0 offen offset:640
    buffer_load_dwordx4 v[164:167], v192, s[32:35], 0 offen offset:672
    s_barrier
    ds_read_b64_tr_b16 v[120:121], v188 offset:0
    ds_read_b64_tr_b16 v[122:123], v188 offset:1024
    ds_read_b64_tr_b16 v[124:125], v189 offset:0
    ds_read_b64_tr_b16 v[126:127], v189 offset:1024
    ds_read_b64_tr_b16 v[128:129], v190 offset:0
    ds_read_b64_tr_b16 v[130:131], v190 offset:1024
    ds_read_b64_tr_b16 v[132:133], v191 offset:0
    ds_read_b64_tr_b16 v[134:135], v191 offset:1024
    ds_read_b64_tr_b16 v[136:137], v188 offset:4096
    ds_read_b64_tr_b16 v[138:139], v188 offset:5120
    ds_read_b64_tr_b16 v[140:141], v189 offset:4096
    ds_read_b64_tr_b16 v[142:143], v189 offset:5120
    ds_read_b64_tr_b16 v[144:145], v190 offset:4096
    ds_read_b64_tr_b16 v[146:147], v190 offset:5120
    ds_read_b64_tr_b16 v[148:149], v191 offset:4096
    ds_read_b64_tr_b16 v[150:151], v191 offset:5120
    s_waitcnt vmcnt(4) lgkmcnt(0)
    v_mfma_f32_32x32x16_bf16 v[32:47], v[120:123], v[168:171], v[32:47]
    v_mfma_f32_32x32x16_bf16 v[48:63], v[124:127], v[168:171], v[48:63]
    v_mfma_f32_32x32x16_bf16 v[64:79], v[128:131], v[168:171], v[64:79]
    v_mfma_f32_32x32x16_bf16 v[80:95], v[132:135], v[168:171], v[80:95]
    v_mfma_f32_32x32x16_bf16 v[32:47], v[136:139], v[172:175], v[32:47]
    v_mfma_f32_32x32x16_bf16 v[48:63], v[140:143], v[172:175], v[48:63]
    v_mfma_f32_32x32x16_bf16 v[64:79], v[144:147], v[172:175], v[64:79]
    v_mfma_f32_32x32x16_bf16 v[80:95], v[148:151], v[172:175], v[80:95]
    buffer_load_dwordx4 v[168:171], v192, s[32:35], 0 offen offset:704
    buffer_load_dwordx4 v[172:175], v192, s[32:35], 0 offen offset:736
    s_barrier
    ds_read_b64_tr_b16 v[120:121], v188 offset:8192
    ds_read_b64_tr_b16 v[122:123], v188 offset:9216
    ds_read_b64_tr_b16 v[124:125], v189 offset:8192
    ds_read_b64_tr_b16 v[126:127], v189 offset:9216
    ds_read_b64_tr_b16 v[128:129], v190 offset:8192
    ds_read_b64_tr_b16 v[130:131], v190 offset:9216
    ds_read_b64_tr_b16 v[132:133], v191 offset:8192
    ds_read_b64_tr_b16 v[134:135], v191 offset:9216
    ds_read_b64_tr_b16 v[136:137], v188 offset:12288
    ds_read_b64_tr_b16 v[138:139], v188 offset:13312
    ds_read_b64_tr_b16 v[140:141], v189 offset:12288
    ds_read_b64_tr_b16 v[142:143], v189 offset:13312
    ds_read_b64_tr_b16 v[144:145], v190 offset:12288
    ds_read_b64_tr_b16 v[146:147], v190 offset:13312
    ds_read_b64_tr_b16 v[148:149], v191 offset:12288
    ds_read_b64_tr_b16 v[150:151], v191 offset:13312
    s_waitcnt vmcnt(4) lgkmcnt(0)
    v_mfma_f32_32x32x16_bf16 v[32:47], v[120:123], v[152:155], v[32:47]
    v_mfma_f32_32x32x16_bf16 v[48:63], v[124:127], v[152:155], v[48:63]
    v_mfma_f32_32x32x16_bf16 v[64:79], v[128:131], v[152:155], v[64:79]
    v_mfma_f32_32x32x16_bf16 v[80:95], v[132:135], v[152:155], v[80:95]
    v_mfma_f32_32x32x16_bf16 v[32:47], v[136:139], v[156:159], v[32:47]
    v_mfma_f32_32x32x16_bf16 v[48:63], v[140:143], v[156:159], v[48:63]
    v_mfma_f32_32x32x16_bf16 v[64:79], v[144:147], v[156:159], v[64:79]
    v_mfma_f32_32x32x16_bf16 v[80:95], v[148:151], v[156:159], v[80:95]
    buffer_load_dwordx4 v[152:155], v192, s[32:35], 0 offen offset:768
    buffer_load_dwordx4 v[156:159], v192, s[32:35], 0 offen offset:800
    s_barrier
    ds_read_b64_tr_b16 v[120:121], v188 offset:16384
    ds_read_b64_tr_b16 v[122:123], v188 offset:17408
    ds_read_b64_tr_b16 v[124:125], v189 offset:16384
    ds_read_b64_tr_b16 v[126:127], v189 offset:17408
    ds_read_b64_tr_b16 v[128:129], v190 offset:16384
    ds_read_b64_tr_b16 v[130:131], v190 offset:17408
    ds_read_b64_tr_b16 v[132:133], v191 offset:16384
    ds_read_b64_tr_b16 v[134:135], v191 offset:17408
    ds_read_b64_tr_b16 v[136:137], v188 offset:20480
    ds_read_b64_tr_b16 v[138:139], v188 offset:21504
    ds_read_b64_tr_b16 v[140:141], v189 offset:20480
    ds_read_b64_tr_b16 v[142:143], v189 offset:21504
    ds_read_b64_tr_b16 v[144:145], v190 offset:20480
    ds_read_b64_tr_b16 v[146:147], v190 offset:21504
    ds_read_b64_tr_b16 v[148:149], v191 offset:20480
    ds_read_b64_tr_b16 v[150:151], v191 offset:21504
    s_waitcnt vmcnt(4) lgkmcnt(0)
    v_mfma_f32_32x32x16_bf16 v[32:47], v[120:123], v[160:163], v[32:47]
    v_mfma_f32_32x32x16_bf16 v[48:63], v[124:127], v[160:163], v[48:63]
    v_mfma_f32_32x32x16_bf16 v[64:79], v[128:131], v[160:163], v[64:79]
    v_mfma_f32_32x32x16_bf16 v[80:95], v[132:135], v[160:163], v[80:95]
    v_mfma_f32_32x32x16_bf16 v[32:47], v[136:139], v[164:167], v[32:47]
    v_mfma_f32_32x32x16_bf16 v[48:63], v[140:143], v[164:167], v[48:63]
    v_mfma_f32_32x32x16_bf16 v[64:79], v[144:147], v[164:167], v[64:79]
    v_mfma_f32_32x32x16_bf16 v[80:95], v[148:151], v[164:167], v[80:95]
    buffer_load_dwordx4 v[160:163], v192, s[32:35], 0 offen offset:832
    buffer_load_dwordx4 v[164:167], v192, s[32:35], 0 offen offset:864
    s_barrier
    ds_read_b64_tr_b16 v[120:121], v188 offset:24576
    ds_read_b64_tr_b16 v[122:123], v188 offset:25600
    ds_read_b64_tr_b16 v[124:125], v189 offset:24576
    ds_read_b64_tr_b16 v[126:127], v189 offset:25600
    ds_read_b64_tr_b16 v[128:129], v190 offset:24576
    ds_read_b64_tr_b16 v[130:131], v190 offset:25600
    ds_read_b64_tr_b16 v[132:133], v191 offset:24576
    ds_read_b64_tr_b16 v[134:135], v191 offset:25600
    ds_read_b64_tr_b16 v[136:137], v188 offset:28672
    ds_read_b64_tr_b16 v[138:139], v188 offset:29696
    ds_read_b64_tr_b16 v[140:141], v189 offset:28672
    ds_read_b64_tr_b16 v[142:143], v189 offset:29696
    ds_read_b64_tr_b16 v[144:145], v190 offset:28672
    ds_read_b64_tr_b16 v[146:147], v190 offset:29696
    ds_read_b64_tr_b16 v[148:149], v191 offset:28672
    ds_read_b64_tr_b16 v[150:151], v191 offset:29696
    s_waitcnt vmcnt(4) lgkmcnt(0)
    v_mfma_f32_32x32x16_bf16 v[32:47], v[120:123], v[168:171], v[32:47]
    v_mfma_f32_32x32x16_bf16 v[48:63], v[124:127], v[168:171], v[48:63]
    v_mfma_f32_32x32x16_bf16 v[64:79], v[128:131], v[168:171], v[64:79]
    v_mfma_f32_32x32x16_bf16 v[80:95], v[132:135], v[168:171], v[80:95]
    v_mfma_f32_32x32x16_bf16 v[32:47], v[136:139], v[172:175], v[32:47]
    v_mfma_f32_32x32x16_bf16 v[48:63], v[140:143], v[172:175], v[48:63]
    v_mfma_f32_32x32x16_bf16 v[64:79], v[144:147], v[172:175], v[64:79]
    v_mfma_f32_32x32x16_bf16 v[80:95], v[148:151], v[172:175], v[80:95]
    buffer_load_dwordx4 v[168:171], v192, s[32:35], 0 offen offset:896
    buffer_load_dwordx4 v[172:175], v192, s[32:35], 0 offen offset:928
    s_barrier
    ds_read_b64_tr_b16 v[120:121], v188 offset:32768
    ds_read_b64_tr_b16 v[122:123], v188 offset:33792
    ds_read_b64_tr_b16 v[124:125], v189 offset:32768
    ds_read_b64_tr_b16 v[126:127], v189 offset:33792
    ds_read_b64_tr_b16 v[128:129], v190 offset:32768
    ds_read_b64_tr_b16 v[130:131], v190 offset:33792
    ds_read_b64_tr_b16 v[132:133], v191 offset:32768
    ds_read_b64_tr_b16 v[134:135], v191 offset:33792
    ds_read_b64_tr_b16 v[136:137], v188 offset:36864
    ds_read_b64_tr_b16 v[138:139], v188 offset:37888
    ds_read_b64_tr_b16 v[140:141], v189 offset:36864
    ds_read_b64_tr_b16 v[142:143], v189 offset:37888
    ds_read_b64_tr_b16 v[144:145], v190 offset:36864
    ds_read_b64_tr_b16 v[146:147], v190 offset:37888
    ds_read_b64_tr_b16 v[148:149], v191 offset:36864
    ds_read_b64_tr_b16 v[150:151], v191 offset:37888
    s_waitcnt vmcnt(4) lgkmcnt(0)
    v_mfma_f32_32x32x16_bf16 v[32:47], v[120:123], v[152:155], v[32:47]
    v_mfma_f32_32x32x16_bf16 v[48:63], v[124:127], v[152:155], v[48:63]
    v_mfma_f32_32x32x16_bf16 v[64:79], v[128:131], v[152:155], v[64:79]
    v_mfma_f32_32x32x16_bf16 v[80:95], v[132:135], v[152:155], v[80:95]
    v_mfma_f32_32x32x16_bf16 v[32:47], v[136:139], v[156:159], v[32:47]
    v_mfma_f32_32x32x16_bf16 v[48:63], v[140:143], v[156:159], v[48:63]
    v_mfma_f32_32x32x16_bf16 v[64:79], v[144:147], v[156:159], v[64:79]
    v_mfma_f32_32x32x16_bf16 v[80:95], v[148:151], v[156:159], v[80:95]
    buffer_load_dwordx4 v[152:155], v192, s[32:35], 0 offen offset:960
    buffer_load_dwordx4 v[156:159], v192, s[32:35], 0 offen offset:992
    s_barrier
    ds_read_b64_tr_b16 v[120:121], v188 offset:40960
    ds_read_b64_tr_b16 v[122:123], v188 offset:41984
    ds_read_b64_tr_b16 v[124:125], v189 offset:40960
    ds_read_b64_tr_b16 v[126:127], v189 offset:41984
    ds_read_b64_tr_b16 v[128:129], v190 offset:40960
    ds_read_b64_tr_b16 v[130:131], v190 offset:41984
    ds_read_b64_tr_b16 v[132:133], v191 offset:40960
    ds_read_b64_tr_b16 v[134:135], v191 offset:41984
    ds_read_b64_tr_b16 v[136:137], v188 offset:45056
    ds_read_b64_tr_b16 v[138:139], v188 offset:46080
    ds_read_b64_tr_b16 v[140:141], v189 offset:45056
    ds_read_b64_tr_b16 v[142:143], v189 offset:46080
    ds_read_b64_tr_b16 v[144:145], v190 offset:45056
    ds_read_b64_tr_b16 v[146:147], v190 offset:46080
    ds_read_b64_tr_b16 v[148:149], v191 offset:45056
    ds_read_b64_tr_b16 v[150:151], v191 offset:46080
    s_waitcnt vmcnt(4) lgkmcnt(0)
    v_mfma_f32_32x32x16_bf16 v[32:47], v[120:123], v[160:163], v[32:47]
    v_mfma_f32_32x32x16_bf16 v[48:63], v[124:127], v[160:163], v[48:63]
    v_mfma_f32_32x32x16_bf16 v[64:79], v[128:131], v[160:163], v[64:79]
    v_mfma_f32_32x32x16_bf16 v[80:95], v[132:135], v[160:163], v[80:95]
    v_mfma_f32_32x32x16_bf16 v[32:47], v[136:139], v[164:167], v[32:47]
    v_mfma_f32_32x32x16_bf16 v[48:63], v[140:143], v[164:167], v[48:63]
    v_mfma_f32_32x32x16_bf16 v[64:79], v[144:147], v[164:167], v[64:79]
    v_mfma_f32_32x32x16_bf16 v[80:95], v[148:151], v[164:167], v[80:95]
    buffer_load_dwordx4 v[160:163], v192, s[32:35], 0 offen offset:1024
    buffer_load_dwordx4 v[164:167], v192, s[32:35], 0 offen offset:1056
    s_barrier
    ds_read_b64_tr_b16 v[120:121], v188 offset:49152
    ds_read_b64_tr_b16 v[122:123], v188 offset:50176
    ds_read_b64_tr_b16 v[124:125], v189 offset:49152
    ds_read_b64_tr_b16 v[126:127], v189 offset:50176
    ds_read_b64_tr_b16 v[128:129], v190 offset:49152
    ds_read_b64_tr_b16 v[130:131], v190 offset:50176
    ds_read_b64_tr_b16 v[132:133], v191 offset:49152
    ds_read_b64_tr_b16 v[134:135], v191 offset:50176
    ds_read_b64_tr_b16 v[136:137], v188 offset:53248
    ds_read_b64_tr_b16 v[138:139], v188 offset:54272
    ds_read_b64_tr_b16 v[140:141], v189 offset:53248
    ds_read_b64_tr_b16 v[142:143], v189 offset:54272
    ds_read_b64_tr_b16 v[144:145], v190 offset:53248
    ds_read_b64_tr_b16 v[146:147], v190 offset:54272
    ds_read_b64_tr_b16 v[148:149], v191 offset:53248
    ds_read_b64_tr_b16 v[150:151], v191 offset:54272
    s_waitcnt vmcnt(4) lgkmcnt(0)
    v_mfma_f32_32x32x16_bf16 v[32:47], v[120:123], v[168:171], v[32:47]
    v_mfma_f32_32x32x16_bf16 v[48:63], v[124:127], v[168:171], v[48:63]
    v_mfma_f32_32x32x16_bf16 v[64:79], v[128:131], v[168:171], v[64:79]
    v_mfma_f32_32x32x16_bf16 v[80:95], v[132:135], v[168:171], v[80:95]
    v_mfma_f32_32x32x16_bf16 v[32:47], v[136:139], v[172:175], v[32:47]
    v_mfma_f32_32x32x16_bf16 v[48:63], v[140:143], v[172:175], v[48:63]
    v_mfma_f32_32x32x16_bf16 v[64:79], v[144:147], v[172:175], v[64:79]
    v_mfma_f32_32x32x16_bf16 v[80:95], v[148:151], v[172:175], v[80:95]
    buffer_load_dwordx4 v[168:171], v192, s[32:35], 0 offen offset:1088
    buffer_load_dwordx4 v[172:175], v192, s[32:35], 0 offen offset:1120
    s_barrier
    ds_read_b64_tr_b16 v[120:121], v188 offset:57344
    ds_read_b64_tr_b16 v[122:123], v188 offset:58368
    ds_read_b64_tr_b16 v[124:125], v189 offset:57344
    ds_read_b64_tr_b16 v[126:127], v189 offset:58368
    ds_read_b64_tr_b16 v[128:129], v190 offset:57344
    ds_read_b64_tr_b16 v[130:131], v190 offset:58368
    ds_read_b64_tr_b16 v[132:133], v191 offset:57344
    ds_read_b64_tr_b16 v[134:135], v191 offset:58368
    ds_read_b64_tr_b16 v[136:137], v188 offset:61440
    ds_read_b64_tr_b16 v[138:139], v188 offset:62464
    ds_read_b64_tr_b16 v[140:141], v189 offset:61440
    ds_read_b64_tr_b16 v[142:143], v189 offset:62464
    ds_read_b64_tr_b16 v[144:145], v190 offset:61440
    ds_read_b64_tr_b16 v[146:147], v190 offset:62464
    ds_read_b64_tr_b16 v[148:149], v191 offset:61440
    ds_read_b64_tr_b16 v[150:151], v191 offset:62464
    s_waitcnt vmcnt(4) lgkmcnt(0)
    v_mfma_f32_32x32x16_bf16 v[32:47], v[120:123], v[152:155], v[32:47]
    v_mfma_f32_32x32x16_bf16 v[48:63], v[124:127], v[152:155], v[48:63]
    v_mfma_f32_32x32x16_bf16 v[64:79], v[128:131], v[152:155], v[64:79]
    v_mfma_f32_32x32x16_bf16 v[80:95], v[132:135], v[152:155], v[80:95]
    v_mfma_f32_32x32x16_bf16 v[32:47], v[136:139], v[156:159], v[32:47]
    v_mfma_f32_32x32x16_bf16 v[48:63], v[140:143], v[156:159], v[48:63]
    v_mfma_f32_32x32x16_bf16 v[64:79], v[144:147], v[156:159], v[64:79]
    v_mfma_f32_32x32x16_bf16 v[80:95], v[148:151], v[156:159], v[80:95]
    buffer_load_dwordx4 v[152:155], v192, s[32:35], 0 offen offset:1152
    buffer_load_dwordx4 v[156:159], v192, s[32:35], 0 offen offset:1184
    s_barrier
    ds_read_b64_tr_b16 v[120:121], v188 offset:0
    ds_read_b64_tr_b16 v[122:123], v188 offset:1024
    ds_read_b64_tr_b16 v[124:125], v189 offset:0
    ds_read_b64_tr_b16 v[126:127], v189 offset:1024
    ds_read_b64_tr_b16 v[128:129], v190 offset:0
    ds_read_b64_tr_b16 v[130:131], v190 offset:1024
    ds_read_b64_tr_b16 v[132:133], v191 offset:0
    ds_read_b64_tr_b16 v[134:135], v191 offset:1024
    ds_read_b64_tr_b16 v[136:137], v188 offset:4096
    ds_read_b64_tr_b16 v[138:139], v188 offset:5120
    ds_read_b64_tr_b16 v[140:141], v189 offset:4096
    ds_read_b64_tr_b16 v[142:143], v189 offset:5120
    ds_read_b64_tr_b16 v[144:145], v190 offset:4096
    ds_read_b64_tr_b16 v[146:147], v190 offset:5120
    ds_read_b64_tr_b16 v[148:149], v191 offset:4096
    ds_read_b64_tr_b16 v[150:151], v191 offset:5120
    s_waitcnt vmcnt(4) lgkmcnt(0)
    v_mfma_f32_32x32x16_bf16 v[32:47], v[120:123], v[160:163], v[32:47]
    v_mfma_f32_32x32x16_bf16 v[48:63], v[124:127], v[160:163], v[48:63]
    v_mfma_f32_32x32x16_bf16 v[64:79], v[128:131], v[160:163], v[64:79]
    v_mfma_f32_32x32x16_bf16 v[80:95], v[132:135], v[160:163], v[80:95]
    v_mfma_f32_32x32x16_bf16 v[32:47], v[136:139], v[164:167], v[32:47]
    v_mfma_f32_32x32x16_bf16 v[48:63], v[140:143], v[164:167], v[48:63]
    v_mfma_f32_32x32x16_bf16 v[64:79], v[144:147], v[164:167], v[64:79]
    v_mfma_f32_32x32x16_bf16 v[80:95], v[148:151], v[164:167], v[80:95]
    buffer_load_dwordx4 v[160:163], v192, s[32:35], 0 offen offset:1216
    buffer_load_dwordx4 v[164:167], v192, s[32:35], 0 offen offset:1248
    s_barrier
    ds_read_b64_tr_b16 v[120:121], v188 offset:8192
    ds_read_b64_tr_b16 v[122:123], v188 offset:9216
    ds_read_b64_tr_b16 v[124:125], v189 offset:8192
    ds_read_b64_tr_b16 v[126:127], v189 offset:9216
    ds_read_b64_tr_b16 v[128:129], v190 offset:8192
    ds_read_b64_tr_b16 v[130:131], v190 offset:9216
    ds_read_b64_tr_b16 v[132:133], v191 offset:8192
    ds_read_b64_tr_b16 v[134:135], v191 offset:9216
    ds_read_b64_tr_b16 v[136:137], v188 offset:12288
    ds_read_b64_tr_b16 v[138:139], v188 offset:13312
    ds_read_b64_tr_b16 v[140:141], v189 offset:12288
    ds_read_b64_tr_b16 v[142:143], v189 offset:13312
    ds_read_b64_tr_b16 v[144:145], v190 offset:12288
    ds_read_b64_tr_b16 v[146:147], v190 offset:13312
    ds_read_b64_tr_b16 v[148:149], v191 offset:12288
    ds_read_b64_tr_b16 v[150:151], v191 offset:13312
    s_waitcnt vmcnt(4) lgkmcnt(0)
    v_mfma_f32_32x32x16_bf16 v[32:47], v[120:123], v[168:171], v[32:47]
    v_mfma_f32_32x32x16_bf16 v[48:63], v[124:127], v[168:171], v[48:63]
    v_mfma_f32_32x32x16_bf16 v[64:79], v[128:131], v[168:171], v[64:79]
    v_mfma_f32_32x32x16_bf16 v[80:95], v[132:135], v[168:171], v[80:95]
    v_mfma_f32_32x32x16_bf16 v[32:47], v[136:139], v[172:175], v[32:47]
    v_mfma_f32_32x32x16_bf16 v[48:63], v[140:143], v[172:175], v[48:63]
    v_mfma_f32_32x32x16_bf16 v[64:79], v[144:147], v[172:175], v[64:79]
    v_mfma_f32_32x32x16_bf16 v[80:95], v[148:151], v[172:175], v[80:95]
    buffer_load_dwordx4 v[168:171], v192, s[32:35], 0 offen offset:1280
    buffer_load_dwordx4 v[172:175], v192, s[32:35], 0 offen offset:1312
    s_barrier
    ds_read_b64_tr_b16 v[120:121], v188 offset:16384
    ds_read_b64_tr_b16 v[122:123], v188 offset:17408
    ds_read_b64_tr_b16 v[124:125], v189 offset:16384
    ds_read_b64_tr_b16 v[126:127], v189 offset:17408
    ds_read_b64_tr_b16 v[128:129], v190 offset:16384
    ds_read_b64_tr_b16 v[130:131], v190 offset:17408
    ds_read_b64_tr_b16 v[132:133], v191 offset:16384
    ds_read_b64_tr_b16 v[134:135], v191 offset:17408
    ds_read_b64_tr_b16 v[136:137], v188 offset:20480
    ds_read_b64_tr_b16 v[138:139], v188 offset:21504
    ds_read_b64_tr_b16 v[140:141], v189 offset:20480
    ds_read_b64_tr_b16 v[142:143], v189 offset:21504
    ds_read_b64_tr_b16 v[144:145], v190 offset:20480
    ds_read_b64_tr_b16 v[146:147], v190 offset:21504
    ds_read_b64_tr_b16 v[148:149], v191 offset:20480
    ds_read_b64_tr_b16 v[150:151], v191 offset:21504
    s_waitcnt vmcnt(4) lgkmcnt(0)
    v_mfma_f32_32x32x16_bf16 v[32:47], v[120:123], v[152:155], v[32:47]
    v_mfma_f32_32x32x16_bf16 v[48:63], v[124:127], v[152:155], v[48:63]
    v_mfma_f32_32x32x16_bf16 v[64:79], v[128:131], v[152:155], v[64:79]
    v_mfma_f32_32x32x16_bf16 v[80:95], v[132:135], v[152:155], v[80:95]
    v_mfma_f32_32x32x16_bf16 v[32:47], v[136:139], v[156:159], v[32:47]
    v_mfma_f32_32x32x16_bf16 v[48:63], v[140:143], v[156:159], v[48:63]
    v_mfma_f32_32x32x16_bf16 v[64:79], v[144:147], v[156:159], v[64:79]
    v_mfma_f32_32x32x16_bf16 v[80:95], v[148:151], v[156:159], v[80:95]
    buffer_load_dwordx4 v[152:155], v192, s[32:35], 0 offen offset:1344
    buffer_load_dwordx4 v[156:159], v192, s[32:35], 0 offen offset:1376
    s_barrier
    ds_read_b64_tr_b16 v[120:121], v188 offset:24576
    ds_read_b64_tr_b16 v[122:123], v188 offset:25600
    ds_read_b64_tr_b16 v[124:125], v189 offset:24576
    ds_read_b64_tr_b16 v[126:127], v189 offset:25600
    ds_read_b64_tr_b16 v[128:129], v190 offset:24576
    ds_read_b64_tr_b16 v[130:131], v190 offset:25600
    ds_read_b64_tr_b16 v[132:133], v191 offset:24576
    ds_read_b64_tr_b16 v[134:135], v191 offset:25600
    ds_read_b64_tr_b16 v[136:137], v188 offset:28672
    ds_read_b64_tr_b16 v[138:139], v188 offset:29696
    ds_read_b64_tr_b16 v[140:141], v189 offset:28672
    ds_read_b64_tr_b16 v[142:143], v189 offset:29696
    ds_read_b64_tr_b16 v[144:145], v190 offset:28672
    ds_read_b64_tr_b16 v[146:147], v190 offset:29696
    ds_read_b64_tr_b16 v[148:149], v191 offset:28672
    ds_read_b64_tr_b16 v[150:151], v191 offset:29696
    s_waitcnt vmcnt(4) lgkmcnt(0)
    v_mfma_f32_32x32x16_bf16 v[32:47], v[120:123], v[160:163], v[32:47]
    v_mfma_f32_32x32x16_bf16 v[48:63], v[124:127], v[160:163], v[48:63]
    v_mfma_f32_32x32x16_bf16 v[64:79], v[128:131], v[160:163], v[64:79]
    v_mfma_f32_32x32x16_bf16 v[80:95], v[132:135], v[160:163], v[80:95]
    v_mfma_f32_32x32x16_bf16 v[32:47], v[136:139], v[164:167], v[32:47]
    v_mfma_f32_32x32x16_bf16 v[48:63], v[140:143], v[164:167], v[48:63]
    v_mfma_f32_32x32x16_bf16 v[64:79], v[144:147], v[164:167], v[64:79]
    v_mfma_f32_32x32x16_bf16 v[80:95], v[148:151], v[164:167], v[80:95]
    buffer_load_dwordx4 v[160:163], v192, s[32:35], 0 offen offset:1408
    buffer_load_dwordx4 v[164:167], v192, s[32:35], 0 offen offset:1440
    s_barrier
    ds_read_b64_tr_b16 v[120:121], v188 offset:32768
    ds_read_b64_tr_b16 v[122:123], v188 offset:33792
    ds_read_b64_tr_b16 v[124:125], v189 offset:32768
    ds_read_b64_tr_b16 v[126:127], v189 offset:33792
    ds_read_b64_tr_b16 v[128:129], v190 offset:32768
    ds_read_b64_tr_b16 v[130:131], v190 offset:33792
    ds_read_b64_tr_b16 v[132:133], v191 offset:32768
    ds_read_b64_tr_b16 v[134:135], v191 offset:33792
    ds_read_b64_tr_b16 v[136:137], v188 offset:36864
    ds_read_b64_tr_b16 v[138:139], v188 offset:37888
    ds_read_b64_tr_b16 v[140:141], v189 offset:36864
    ds_read_b64_tr_b16 v[142:143], v189 offset:37888
    ds_read_b64_tr_b16 v[144:145], v190 offset:36864
    ds_read_b64_tr_b16 v[146:147], v190 offset:37888
    ds_read_b64_tr_b16 v[148:149], v191 offset:36864
    ds_read_b64_tr_b16 v[150:151], v191 offset:37888
    s_waitcnt vmcnt(4) lgkmcnt(0)
    v_mfma_f32_32x32x16_bf16 v[32:47], v[120:123], v[168:171], v[32:47]
    v_mfma_f32_32x32x16_bf16 v[48:63], v[124:127], v[168:171], v[48:63]
    v_mfma_f32_32x32x16_bf16 v[64:79], v[128:131], v[168:171], v[64:79]
    v_mfma_f32_32x32x16_bf16 v[80:95], v[132:135], v[168:171], v[80:95]
    v_mfma_f32_32x32x16_bf16 v[32:47], v[136:139], v[172:175], v[32:47]
    v_mfma_f32_32x32x16_bf16 v[48:63], v[140:143], v[172:175], v[48:63]
    v_mfma_f32_32x32x16_bf16 v[64:79], v[144:147], v[172:175], v[64:79]
    v_mfma_f32_32x32x16_bf16 v[80:95], v[148:151], v[172:175], v[80:95]
    buffer_load_dwordx4 v[168:171], v192, s[32:35], 0 offen offset:1472
    buffer_load_dwordx4 v[172:175], v192, s[32:35], 0 offen offset:1504
    s_barrier
    ds_read_b64_tr_b16 v[120:121], v188 offset:40960
    ds_read_b64_tr_b16 v[122:123], v188 offset:41984
    ds_read_b64_tr_b16 v[124:125], v189 offset:40960
    ds_read_b64_tr_b16 v[126:127], v189 offset:41984
    ds_read_b64_tr_b16 v[128:129], v190 offset:40960
    ds_read_b64_tr_b16 v[130:131], v190 offset:41984
    ds_read_b64_tr_b16 v[132:133], v191 offset:40960
    ds_read_b64_tr_b16 v[134:135], v191 offset:41984
    ds_read_b64_tr_b16 v[136:137], v188 offset:45056
    ds_read_b64_tr_b16 v[138:139], v188 offset:46080
    ds_read_b64_tr_b16 v[140:141], v189 offset:45056
    ds_read_b64_tr_b16 v[142:143], v189 offset:46080
    ds_read_b64_tr_b16 v[144:145], v190 offset:45056
    ds_read_b64_tr_b16 v[146:147], v190 offset:46080
    ds_read_b64_tr_b16 v[148:149], v191 offset:45056
    ds_read_b64_tr_b16 v[150:151], v191 offset:46080
    s_waitcnt vmcnt(4) lgkmcnt(0)
    v_mfma_f32_32x32x16_bf16 v[32:47], v[120:123], v[152:155], v[32:47]
    v_mfma_f32_32x32x16_bf16 v[48:63], v[124:127], v[152:155], v[48:63]
    v_mfma_f32_32x32x16_bf16 v[64:79], v[128:131], v[152:155], v[64:79]
    v_mfma_f32_32x32x16_bf16 v[80:95], v[132:135], v[152:155], v[80:95]
    v_mfma_f32_32x32x16_bf16 v[32:47], v[136:139], v[156:159], v[32:47]
    v_mfma_f32_32x32x16_bf16 v[48:63], v[140:143], v[156:159], v[48:63]
    v_mfma_f32_32x32x16_bf16 v[64:79], v[144:147], v[156:159], v[64:79]
    v_mfma_f32_32x32x16_bf16 v[80:95], v[148:151], v[156:159], v[80:95]
    buffer_load_dwordx4 v[152:155], v192, s[32:35], 0 offen offset:1536
    buffer_load_dwordx4 v[156:159], v192, s[32:35], 0 offen offset:1568
    s_barrier
    ds_read_b64_tr_b16 v[120:121], v188 offset:49152
    ds_read_b64_tr_b16 v[122:123], v188 offset:50176
    ds_read_b64_tr_b16 v[124:125], v189 offset:49152
    ds_read_b64_tr_b16 v[126:127], v189 offset:50176
    ds_read_b64_tr_b16 v[128:129], v190 offset:49152
    ds_read_b64_tr_b16 v[130:131], v190 offset:50176
    ds_read_b64_tr_b16 v[132:133], v191 offset:49152
    ds_read_b64_tr_b16 v[134:135], v191 offset:50176
    ds_read_b64_tr_b16 v[136:137], v188 offset:53248
    ds_read_b64_tr_b16 v[138:139], v188 offset:54272
    ds_read_b64_tr_b16 v[140:141], v189 offset:53248
    ds_read_b64_tr_b16 v[142:143], v189 offset:54272
    ds_read_b64_tr_b16 v[144:145], v190 offset:53248
    ds_read_b64_tr_b16 v[146:147], v190 offset:54272
    ds_read_b64_tr_b16 v[148:149], v191 offset:53248
    ds_read_b64_tr_b16 v[150:151], v191 offset:54272
    s_waitcnt vmcnt(4) lgkmcnt(0)
    v_mfma_f32_32x32x16_bf16 v[32:47], v[120:123], v[160:163], v[32:47]
    v_mfma_f32_32x32x16_bf16 v[48:63], v[124:127], v[160:163], v[48:63]
    v_mfma_f32_32x32x16_bf16 v[64:79], v[128:131], v[160:163], v[64:79]
    v_mfma_f32_32x32x16_bf16 v[80:95], v[132:135], v[160:163], v[80:95]
    v_mfma_f32_32x32x16_bf16 v[32:47], v[136:139], v[164:167], v[32:47]
    v_mfma_f32_32x32x16_bf16 v[48:63], v[140:143], v[164:167], v[48:63]
    v_mfma_f32_32x32x16_bf16 v[64:79], v[144:147], v[164:167], v[64:79]
    v_mfma_f32_32x32x16_bf16 v[80:95], v[148:151], v[164:167], v[80:95]
    buffer_load_dwordx4 v[160:163], v192, s[32:35], 0 offen offset:1600
    buffer_load_dwordx4 v[164:167], v192, s[32:35], 0 offen offset:1632
    s_barrier
    ds_read_b64_tr_b16 v[120:121], v188 offset:57344
    ds_read_b64_tr_b16 v[122:123], v188 offset:58368
    ds_read_b64_tr_b16 v[124:125], v189 offset:57344
    ds_read_b64_tr_b16 v[126:127], v189 offset:58368
    ds_read_b64_tr_b16 v[128:129], v190 offset:57344
    ds_read_b64_tr_b16 v[130:131], v190 offset:58368
    ds_read_b64_tr_b16 v[132:133], v191 offset:57344
    ds_read_b64_tr_b16 v[134:135], v191 offset:58368
    ds_read_b64_tr_b16 v[136:137], v188 offset:61440
    ds_read_b64_tr_b16 v[138:139], v188 offset:62464
    ds_read_b64_tr_b16 v[140:141], v189 offset:61440
    ds_read_b64_tr_b16 v[142:143], v189 offset:62464
    ds_read_b64_tr_b16 v[144:145], v190 offset:61440
    ds_read_b64_tr_b16 v[146:147], v190 offset:62464
    ds_read_b64_tr_b16 v[148:149], v191 offset:61440
    ds_read_b64_tr_b16 v[150:151], v191 offset:62464
    s_waitcnt vmcnt(4) lgkmcnt(0)
    v_mfma_f32_32x32x16_bf16 v[32:47], v[120:123], v[168:171], v[32:47]
    v_mfma_f32_32x32x16_bf16 v[48:63], v[124:127], v[168:171], v[48:63]
    v_mfma_f32_32x32x16_bf16 v[64:79], v[128:131], v[168:171], v[64:79]
    v_mfma_f32_32x32x16_bf16 v[80:95], v[132:135], v[168:171], v[80:95]
    v_mfma_f32_32x32x16_bf16 v[32:47], v[136:139], v[172:175], v[32:47]
    v_mfma_f32_32x32x16_bf16 v[48:63], v[140:143], v[172:175], v[48:63]
    v_mfma_f32_32x32x16_bf16 v[64:79], v[144:147], v[172:175], v[64:79]
    v_mfma_f32_32x32x16_bf16 v[80:95], v[148:151], v[172:175], v[80:95]
    buffer_load_dwordx4 v[168:171], v192, s[32:35], 0 offen offset:1664
    buffer_load_dwordx4 v[172:175], v192, s[32:35], 0 offen offset:1696
    s_barrier
    ds_read_b64_tr_b16 v[120:121], v188 offset:0
    ds_read_b64_tr_b16 v[122:123], v188 offset:1024
    ds_read_b64_tr_b16 v[124:125], v189 offset:0
    ds_read_b64_tr_b16 v[126:127], v189 offset:1024
    ds_read_b64_tr_b16 v[128:129], v190 offset:0
    ds_read_b64_tr_b16 v[130:131], v190 offset:1024
    ds_read_b64_tr_b16 v[132:133], v191 offset:0
    ds_read_b64_tr_b16 v[134:135], v191 offset:1024
    ds_read_b64_tr_b16 v[136:137], v188 offset:4096
    ds_read_b64_tr_b16 v[138:139], v188 offset:5120
    ds_read_b64_tr_b16 v[140:141], v189 offset:4096
    ds_read_b64_tr_b16 v[142:143], v189 offset:5120
    ds_read_b64_tr_b16 v[144:145], v190 offset:4096
    ds_read_b64_tr_b16 v[146:147], v190 offset:5120
    ds_read_b64_tr_b16 v[148:149], v191 offset:4096
    ds_read_b64_tr_b16 v[150:151], v191 offset:5120
    s_waitcnt vmcnt(4) lgkmcnt(0)
    v_mfma_f32_32x32x16_bf16 v[32:47], v[120:123], v[152:155], v[32:47]
    v_mfma_f32_32x32x16_bf16 v[48:63], v[124:127], v[152:155], v[48:63]
    v_mfma_f32_32x32x16_bf16 v[64:79], v[128:131], v[152:155], v[64:79]
    v_mfma_f32_32x32x16_bf16 v[80:95], v[132:135], v[152:155], v[80:95]
    v_mfma_f32_32x32x16_bf16 v[32:47], v[136:139], v[156:159], v[32:47]
    v_mfma_f32_32x32x16_bf16 v[48:63], v[140:143], v[156:159], v[48:63]
    v_mfma_f32_32x32x16_bf16 v[64:79], v[144:147], v[156:159], v[64:79]
    v_mfma_f32_32x32x16_bf16 v[80:95], v[148:151], v[156:159], v[80:95]
    buffer_load_dwordx4 v[152:155], v192, s[32:35], 0 offen offset:1728
    buffer_load_dwordx4 v[156:159], v192, s[32:35], 0 offen offset:1760
    s_barrier
    ds_read_b64_tr_b16 v[120:121], v188 offset:8192
    ds_read_b64_tr_b16 v[122:123], v188 offset:9216
    ds_read_b64_tr_b16 v[124:125], v189 offset:8192
    ds_read_b64_tr_b16 v[126:127], v189 offset:9216
    ds_read_b64_tr_b16 v[128:129], v190 offset:8192
    ds_read_b64_tr_b16 v[130:131], v190 offset:9216
    ds_read_b64_tr_b16 v[132:133], v191 offset:8192
    ds_read_b64_tr_b16 v[134:135], v191 offset:9216
    ds_read_b64_tr_b16 v[136:137], v188 offset:12288
    ds_read_b64_tr_b16 v[138:139], v188 offset:13312
    ds_read_b64_tr_b16 v[140:141], v189 offset:12288
    ds_read_b64_tr_b16 v[142:143], v189 offset:13312
    ds_read_b64_tr_b16 v[144:145], v190 offset:12288
    ds_read_b64_tr_b16 v[146:147], v190 offset:13312
    ds_read_b64_tr_b16 v[148:149], v191 offset:12288
    ds_read_b64_tr_b16 v[150:151], v191 offset:13312
    s_waitcnt vmcnt(4) lgkmcnt(0)
    v_mfma_f32_32x32x16_bf16 v[32:47], v[120:123], v[160:163], v[32:47]
    v_mfma_f32_32x32x16_bf16 v[48:63], v[124:127], v[160:163], v[48:63]
    v_mfma_f32_32x32x16_bf16 v[64:79], v[128:131], v[160:163], v[64:79]
    v_mfma_f32_32x32x16_bf16 v[80:95], v[132:135], v[160:163], v[80:95]
    v_mfma_f32_32x32x16_bf16 v[32:47], v[136:139], v[164:167], v[32:47]
    v_mfma_f32_32x32x16_bf16 v[48:63], v[140:143], v[164:167], v[48:63]
    v_mfma_f32_32x32x16_bf16 v[64:79], v[144:147], v[164:167], v[64:79]
    v_mfma_f32_32x32x16_bf16 v[80:95], v[148:151], v[164:167], v[80:95]
    buffer_load_dwordx4 v[160:163], v192, s[32:35], 0 offen offset:1792
    buffer_load_dwordx4 v[164:167], v192, s[32:35], 0 offen offset:1824
    s_barrier
    ds_read_b64_tr_b16 v[120:121], v188 offset:16384
    ds_read_b64_tr_b16 v[122:123], v188 offset:17408
    ds_read_b64_tr_b16 v[124:125], v189 offset:16384
    ds_read_b64_tr_b16 v[126:127], v189 offset:17408
    ds_read_b64_tr_b16 v[128:129], v190 offset:16384
    ds_read_b64_tr_b16 v[130:131], v190 offset:17408
    ds_read_b64_tr_b16 v[132:133], v191 offset:16384
    ds_read_b64_tr_b16 v[134:135], v191 offset:17408
    ds_read_b64_tr_b16 v[136:137], v188 offset:20480
    ds_read_b64_tr_b16 v[138:139], v188 offset:21504
    ds_read_b64_tr_b16 v[140:141], v189 offset:20480
    ds_read_b64_tr_b16 v[142:143], v189 offset:21504
    ds_read_b64_tr_b16 v[144:145], v190 offset:20480
    ds_read_b64_tr_b16 v[146:147], v190 offset:21504
    ds_read_b64_tr_b16 v[148:149], v191 offset:20480
    ds_read_b64_tr_b16 v[150:151], v191 offset:21504
    s_waitcnt vmcnt(4) lgkmcnt(0)
    v_mfma_f32_32x32x16_bf16 v[32:47], v[120:123], v[168:171], v[32:47]
    v_mfma_f32_32x32x16_bf16 v[48:63], v[124:127], v[168:171], v[48:63]
    v_mfma_f32_32x32x16_bf16 v[64:79], v[128:131], v[168:171], v[64:79]
    v_mfma_f32_32x32x16_bf16 v[80:95], v[132:135], v[168:171], v[80:95]
    v_mfma_f32_32x32x16_bf16 v[32:47], v[136:139], v[172:175], v[32:47]
    v_mfma_f32_32x32x16_bf16 v[48:63], v[140:143], v[172:175], v[48:63]
    v_mfma_f32_32x32x16_bf16 v[64:79], v[144:147], v[172:175], v[64:79]
    v_mfma_f32_32x32x16_bf16 v[80:95], v[148:151], v[172:175], v[80:95]
    buffer_load_dwordx4 v[168:171], v192, s[32:35], 0 offen offset:1856
    buffer_load_dwordx4 v[172:175], v192, s[32:35], 0 offen offset:1888
    s_barrier
    ds_read_b64_tr_b16 v[120:121], v188 offset:24576
    ds_read_b64_tr_b16 v[122:123], v188 offset:25600
    ds_read_b64_tr_b16 v[124:125], v189 offset:24576
    ds_read_b64_tr_b16 v[126:127], v189 offset:25600
    ds_read_b64_tr_b16 v[128:129], v190 offset:24576
    ds_read_b64_tr_b16 v[130:131], v190 offset:25600
    ds_read_b64_tr_b16 v[132:133], v191 offset:24576
    ds_read_b64_tr_b16 v[134:135], v191 offset:25600
    ds_read_b64_tr_b16 v[136:137], v188 offset:28672
    ds_read_b64_tr_b16 v[138:139], v188 offset:29696
    ds_read_b64_tr_b16 v[140:141], v189 offset:28672
    ds_read_b64_tr_b16 v[142:143], v189 offset:29696
    ds_read_b64_tr_b16 v[144:145], v190 offset:28672
    ds_read_b64_tr_b16 v[146:147], v190 offset:29696
    ds_read_b64_tr_b16 v[148:149], v191 offset:28672
    ds_read_b64_tr_b16 v[150:151], v191 offset:29696
    s_waitcnt vmcnt(4) lgkmcnt(0)
    v_mfma_f32_32x32x16_bf16 v[32:47], v[120:123], v[152:155], v[32:47]
    v_mfma_f32_32x32x16_bf16 v[48:63], v[124:127], v[152:155], v[48:63]
    v_mfma_f32_32x32x16_bf16 v[64:79], v[128:131], v[152:155], v[64:79]
    v_mfma_f32_32x32x16_bf16 v[80:95], v[132:135], v[152:155], v[80:95]
    v_mfma_f32_32x32x16_bf16 v[32:47], v[136:139], v[156:159], v[32:47]
    v_mfma_f32_32x32x16_bf16 v[48:63], v[140:143], v[156:159], v[48:63]
    v_mfma_f32_32x32x16_bf16 v[64:79], v[144:147], v[156:159], v[64:79]
    v_mfma_f32_32x32x16_bf16 v[80:95], v[148:151], v[156:159], v[80:95]
    buffer_load_dwordx4 v[152:155], v192, s[32:35], 0 offen offset:1920
    buffer_load_dwordx4 v[156:159], v192, s[32:35], 0 offen offset:1952
    s_barrier
    ds_read_b64_tr_b16 v[120:121], v188 offset:32768
    ds_read_b64_tr_b16 v[122:123], v188 offset:33792
    ds_read_b64_tr_b16 v[124:125], v189 offset:32768
    ds_read_b64_tr_b16 v[126:127], v189 offset:33792
    ds_read_b64_tr_b16 v[128:129], v190 offset:32768
    ds_read_b64_tr_b16 v[130:131], v190 offset:33792
    ds_read_b64_tr_b16 v[132:133], v191 offset:32768
    ds_read_b64_tr_b16 v[134:135], v191 offset:33792
    ds_read_b64_tr_b16 v[136:137], v188 offset:36864
    ds_read_b64_tr_b16 v[138:139], v188 offset:37888
    ds_read_b64_tr_b16 v[140:141], v189 offset:36864
    ds_read_b64_tr_b16 v[142:143], v189 offset:37888
    ds_read_b64_tr_b16 v[144:145], v190 offset:36864
    ds_read_b64_tr_b16 v[146:147], v190 offset:37888
    ds_read_b64_tr_b16 v[148:149], v191 offset:36864
    ds_read_b64_tr_b16 v[150:151], v191 offset:37888
    s_waitcnt vmcnt(4) lgkmcnt(0)
    v_mfma_f32_32x32x16_bf16 v[32:47], v[120:123], v[160:163], v[32:47]
    v_mfma_f32_32x32x16_bf16 v[48:63], v[124:127], v[160:163], v[48:63]
    v_mfma_f32_32x32x16_bf16 v[64:79], v[128:131], v[160:163], v[64:79]
    v_mfma_f32_32x32x16_bf16 v[80:95], v[132:135], v[160:163], v[80:95]
    v_mfma_f32_32x32x16_bf16 v[32:47], v[136:139], v[164:167], v[32:47]
    v_mfma_f32_32x32x16_bf16 v[48:63], v[140:143], v[164:167], v[48:63]
    v_mfma_f32_32x32x16_bf16 v[64:79], v[144:147], v[164:167], v[64:79]
    v_mfma_f32_32x32x16_bf16 v[80:95], v[148:151], v[164:167], v[80:95]
    buffer_load_dwordx4 v[160:163], v192, s[32:35], 0 offen offset:1984
    buffer_load_dwordx4 v[164:167], v192, s[32:35], 0 offen offset:2016
    s_barrier
    ds_read_b64_tr_b16 v[120:121], v188 offset:40960
    ds_read_b64_tr_b16 v[122:123], v188 offset:41984
    ds_read_b64_tr_b16 v[124:125], v189 offset:40960
    ds_read_b64_tr_b16 v[126:127], v189 offset:41984
    ds_read_b64_tr_b16 v[128:129], v190 offset:40960
    ds_read_b64_tr_b16 v[130:131], v190 offset:41984
    ds_read_b64_tr_b16 v[132:133], v191 offset:40960
    ds_read_b64_tr_b16 v[134:135], v191 offset:41984
    ds_read_b64_tr_b16 v[136:137], v188 offset:45056
    ds_read_b64_tr_b16 v[138:139], v188 offset:46080
    ds_read_b64_tr_b16 v[140:141], v189 offset:45056
    ds_read_b64_tr_b16 v[142:143], v189 offset:46080
    ds_read_b64_tr_b16 v[144:145], v190 offset:45056
    ds_read_b64_tr_b16 v[146:147], v190 offset:46080
    ds_read_b64_tr_b16 v[148:149], v191 offset:45056
    ds_read_b64_tr_b16 v[150:151], v191 offset:46080
    s_waitcnt vmcnt(4) lgkmcnt(0)
    v_mfma_f32_32x32x16_bf16 v[32:47], v[120:123], v[168:171], v[32:47]
    v_mfma_f32_32x32x16_bf16 v[48:63], v[124:127], v[168:171], v[48:63]
    v_mfma_f32_32x32x16_bf16 v[64:79], v[128:131], v[168:171], v[64:79]
    v_mfma_f32_32x32x16_bf16 v[80:95], v[132:135], v[168:171], v[80:95]
    v_mfma_f32_32x32x16_bf16 v[32:47], v[136:139], v[172:175], v[32:47]
    v_mfma_f32_32x32x16_bf16 v[48:63], v[140:143], v[172:175], v[48:63]
    v_mfma_f32_32x32x16_bf16 v[64:79], v[144:147], v[172:175], v[64:79]
    v_mfma_f32_32x32x16_bf16 v[80:95], v[148:151], v[172:175], v[80:95]
    s_barrier
    ds_read_b64_tr_b16 v[120:121], v188 offset:49152
    ds_read_b64_tr_b16 v[122:123], v188 offset:50176
    ds_read_b64_tr_b16 v[124:125], v189 offset:49152
    ds_read_b64_tr_b16 v[126:127], v189 offset:50176
    ds_read_b64_tr_b16 v[128:129], v190 offset:49152
    ds_read_b64_tr_b16 v[130:131], v190 offset:50176
    ds_read_b64_tr_b16 v[132:133], v191 offset:49152
    ds_read_b64_tr_b16 v[134:135], v191 offset:50176
    ds_read_b64_tr_b16 v[136:137], v188 offset:53248
    ds_read_b64_tr_b16 v[138:139], v188 offset:54272
    ds_read_b64_tr_b16 v[140:141], v189 offset:53248
    ds_read_b64_tr_b16 v[142:143], v189 offset:54272
    ds_read_b64_tr_b16 v[144:145], v190 offset:53248
    ds_read_b64_tr_b16 v[146:147], v190 offset:54272
    ds_read_b64_tr_b16 v[148:149], v191 offset:53248
    ds_read_b64_tr_b16 v[150:151], v191 offset:54272
    s_waitcnt vmcnt(2) lgkmcnt(0)
    v_mfma_f32_32x32x16_bf16 v[32:47], v[120:123], v[152:155], v[32:47]
    v_mfma_f32_32x32x16_bf16 v[48:63], v[124:127], v[152:155], v[48:63]
    v_mfma_f32_32x32x16_bf16 v[64:79], v[128:131], v[152:155], v[64:79]
    v_mfma_f32_32x32x16_bf16 v[80:95], v[132:135], v[152:155], v[80:95]
    v_mfma_f32_32x32x16_bf16 v[32:47], v[136:139], v[156:159], v[32:47]
    v_mfma_f32_32x32x16_bf16 v[48:63], v[140:143], v[156:159], v[48:63]
    v_mfma_f32_32x32x16_bf16 v[64:79], v[144:147], v[156:159], v[64:79]
    v_mfma_f32_32x32x16_bf16 v[80:95], v[148:151], v[156:159], v[80:95]
    s_barrier
    ds_read_b64_tr_b16 v[120:121], v188 offset:57344
    ds_read_b64_tr_b16 v[122:123], v188 offset:58368
    ds_read_b64_tr_b16 v[124:125], v189 offset:57344
    ds_read_b64_tr_b16 v[126:127], v189 offset:58368
    ds_read_b64_tr_b16 v[128:129], v190 offset:57344
    ds_read_b64_tr_b16 v[130:131], v190 offset:58368
    ds_read_b64_tr_b16 v[132:133], v191 offset:57344
    ds_read_b64_tr_b16 v[134:135], v191 offset:58368
    ds_read_b64_tr_b16 v[136:137], v188 offset:61440
    ds_read_b64_tr_b16 v[138:139], v188 offset:62464
    ds_read_b64_tr_b16 v[140:141], v189 offset:61440
    ds_read_b64_tr_b16 v[142:143], v189 offset:62464
    ds_read_b64_tr_b16 v[144:145], v190 offset:61440
    ds_read_b64_tr_b16 v[146:147], v190 offset:62464
    ds_read_b64_tr_b16 v[148:149], v191 offset:61440
    ds_read_b64_tr_b16 v[150:151], v191 offset:62464
    s_waitcnt vmcnt(0) lgkmcnt(0)
    v_mfma_f32_32x32x16_bf16 v[32:47], v[120:123], v[160:163], v[32:47]
    v_mfma_f32_32x32x16_bf16 v[48:63], v[124:127], v[160:163], v[48:63]
    v_mfma_f32_32x32x16_bf16 v[64:79], v[128:131], v[160:163], v[64:79]
    v_mfma_f32_32x32x16_bf16 v[80:95], v[132:135], v[160:163], v[80:95]
    v_mfma_f32_32x32x16_bf16 v[32:47], v[136:139], v[164:167], v[32:47]
    v_mfma_f32_32x32x16_bf16 v[48:63], v[140:143], v[164:167], v[48:63]
    v_mfma_f32_32x32x16_bf16 v[64:79], v[144:147], v[164:167], v[64:79]
    v_mfma_f32_32x32x16_bf16 v[80:95], v[148:151], v[164:167], v[80:95]
    s_nop 15
    buffer_store_dwordx4 v[32:35], v199, s[36:39], 0 offen offset:0
    buffer_store_dwordx4 v[36:39], v199, s[36:39], 0 offen offset:16
    buffer_store_dwordx4 v[40:43], v199, s[36:39], 0 offen offset:64
    buffer_store_dwordx4 v[44:47], v199, s[36:39], 0 offen offset:80
    buffer_store_dwordx4 v[48:51], v199, s[36:39], 0 offen offset:128
    buffer_store_dwordx4 v[52:55], v199, s[36:39], 0 offen offset:144
    buffer_store_dwordx4 v[56:59], v199, s[36:39], 0 offen offset:192
    buffer_store_dwordx4 v[60:63], v199, s[36:39], 0 offen offset:208
    buffer_store_dwordx4 v[64:67], v199, s[36:39], 0 offen offset:256
    buffer_store_dwordx4 v[68:71], v199, s[36:39], 0 offen offset:272
    buffer_store_dwordx4 v[72:75], v199, s[36:39], 0 offen offset:320
    buffer_store_dwordx4 v[76:79], v199, s[36:39], 0 offen offset:336
    buffer_store_dwordx4 v[80:83], v199, s[36:39], 0 offen offset:384
    buffer_store_dwordx4 v[84:87], v199, s[36:39], 0 offen offset:400
    buffer_store_dwordx4 v[88:91], v199, s[36:39], 0 offen offset:448
    buffer_store_dwordx4 v[92:95], v199, s[36:39], 0 offen offset:464
    s_branch B_end
B_prod:
    s_mul_i32 s46, s2, 5
    s_lshr_b32 s47, s2, 4
    s_add_u32 s46, s46, s47
    s_and_b32 s46, s46, 15
    v_lshrrev_b32 v2, 4, v200
    v_and_b32 v3, 15, v200
    s_mov_b32 s42, 1024
    v_lshlrev_b32 v4, 2, v2
    v_xor_b32 v4, v4, v3
    v_lshlrev_b32 v4, 4, v4
    v_add_u32 v5, 0, v2
    v_and_b32 v6, 15, v5
    v_xor_b32 v6, v6, v3
    v_lshlrev_b32 v6, 4, v6
    v_lshl_add_u32 v8, v5, 8, v6
    v_lshl_add_u32 v16, v5, 8, v4
    v_mul_lo_u32 v6, v5, s42
    v_add_u32 v24, v6, v4
    v_add_u32 v5, 4, v2
    v_and_b32 v6, 15, v5
    v_xor_b32 v6, v6, v3
    v_lshlrev_b32 v6, 4, v6
    v_lshl_add_u32 v9, v5, 8, v6
    v_lshl_add_u32 v17, v5, 8, v4
    v_mul_lo_u32 v6, v5, s42
    v_add_u32 v25, v6, v4
    v_add_u32 v5, 8, v2
    v_and_b32 v6, 15, v5
    v_xor_b32 v6, v6, v3
    v_lshlrev_b32 v6, 4, v6
    v_lshl_add_u32 v10, v5, 8, v6
    v_lshl_add_u32 v18, v5, 8, v4
    v_mul_lo_u32 v6, v5, s42
    v_add_u32 v26, v6, v4
    v_add_u32 v5, 12, v2
    v_and_b32 v6, 15, v5
    v_xor_b32 v6, v6, v3
    v_lshlrev_b32 v6, 4, v6
    v_lshl_add_u32 v11, v5, 8, v6
    v_lshl_add_u32 v19, v5, 8, v4
    v_mul_lo_u32 v6, v5, s42
    v_add_u32 v27, v6, v4
    v_add_u32 v5, 16, v2
    v_and_b32 v6, 15, v5
    v_xor_b32 v6, v6, v3
    v_lshlrev_b32 v6, 4, v6
    v_lshl_add_u32 v12, v5, 8, v6
    v_lshl_add_u32 v20, v5, 8, v4
    v_mul_lo_u32 v6, v5, s42
    v_add_u32 v28, v6, v4
    v_add_u32 v5, 20, v2
    v_and_b32 v6, 15, v5
    v_xor_b32 v6, v6, v3
    v_lshlrev_b32 v6, 4, v6
    v_lshl_add_u32 v13, v5, 8, v6
    v_lshl_add_u32 v21, v5, 8, v4
    v_mul_lo_u32 v6, v5, s42
    v_add_u32 v29, v6, v4
    v_add_u32 v5, 24, v2
    v_and_b32 v6, 15, v5
    v_xor_b32 v6, v6, v3
    v_lshlrev_b32 v6, 4, v6
    v_lshl_add_u32 v14, v5, 8, v6
    v_lshl_add_u32 v22, v5, 8, v4
    v_mul_lo_u32 v6, v5, s42
    v_add_u32 v30, v6, v4
    v_add_u32 v5, 28, v2
    v_and_b32 v6, 15, v5
    v_xor_b32 v6, v6, v3
    v_lshlrev_b32 v6, 4, v6
    v_lshl_add_u32 v15, v5, 8, v6
    v_lshl_add_u32 v23, v5, 8, v4
    v_mul_lo_u32 v6, v5, s42
    v_add_u32 v31, v6, v4
    s_mov_b32 s41, 0
    s_mov_b32 m0, 0
    s_nop 0
    buffer_load_dwordx4 v24, s[28:31], s41 offen lds
    s_mov_b32 m0, 1024
    s_nop 0
    buffer_load_dwordx4 v25, s[28:31], s41 offen lds
    s_mov_b32 m0, 2048
    s_nop 0
    buffer_load_dwordx4 v26, s[28:31], s41 offen lds
    s_mov_b32 m0, 3072
    s_nop 0
    buffer_load_dwordx4 v27, s[28:31], s41 offen lds
    s_mov_b32 m0, 4096
    s_nop 0
    buffer_load_dwordx4 v28, s[28:31], s41 offen lds
    s_mov_b32 m0, 5120
    s_nop 0
    buffer_load_dwordx4 v29, s[28:31], s41 offen lds
    s_mov_b32 m0, 6144
    s_nop 0
    buffer_load_dwordx4 v30, s[28:31], s41 offen lds
    s_mov_b32 m0, 7168
    s_nop 0
    buffer_load_dwordx4 v31, s[28:31], s41 offen lds
    s_mov_b32 s41, 32768
    s_mov_b32 m0, 8192
    s_nop 0
    buffer_load_dwordx4 v24, s[28:31], s41 offen lds
    s_mov_b32 m0, 9216
    s_nop 0
    buffer_load_dwordx4 v25, s[28:31], s41 offen lds
    s_mov_b32 m0, 10240
    s_nop 0
    buffer_load_dwordx4 v26, s[28:31], s41 offen lds
    s_mov_b32 m0, 11264
    s_nop 0
    buffer_load_dwordx4 v27, s[28:31], s41 offen lds
    s_mov_b32 m0, 12288
    s_nop 0
    buffer_load_dwordx4 v28, s[28:31], s41 offen lds
    s_mov_b32 m0, 13312
    s_nop 0
    buffer_load_dwordx4 v29, s[28:31], s41 offen lds
    s_mov_b32 m0, 14336
    s_nop 0
    buffer_load_dwordx4 v30, s[28:31], s41 offen lds
    s_mov_b32 m0, 15360
    s_nop 0
    buffer_load_dwordx4 v31, s[28:31], s41 offen lds
    s_mov_b32 s41, 65536
    s_mov_b32 m0, 16384
    s_nop 0
    buffer_load_dwordx4 v24, s[28:31], s41 offen lds
    s_mov_b32 m0, 17408
    s_nop 0
    buffer_load_dwordx4 v25, s[28:31], s41 offen lds
    s_mov_b32 m0, 18432
    s_nop 0
    buffer_load_dwordx4 v26, s[28:31], s41 offen lds
    s_mov_b32 m0, 19456
    s_nop 0
    buffer_load_dwordx4 v27, s[28:31], s41 offen lds
    s_mov_b32 m0, 20480
    s_nop 0
    buffer_load_dwordx4 v28, s[28:31], s41 offen lds
    s_mov_b32 m0, 21504
    s_nop 0
    buffer_load_dwordx4 v29, s[28:31], s41 offen lds
    s_mov_b32 m0, 22528
    s_nop 0
    buffer_load_dwordx4 v30, s[28:31], s41 offen lds
    s_mov_b32 m0, 23552
    s_nop 0
    buffer_load_dwordx4 v31, s[28:31], s41 offen lds
    s_mov_b32 s41, 98304
    s_mov_b32 m0, 24576
    s_nop 0
    buffer_load_dwordx4 v24, s[28:31], s41 offen lds
    s_mov_b32 m0, 25600
    s_nop 0
    buffer_load_dwordx4 v25, s[28:31], s41 offen lds
    s_mov_b32 m0, 26624
    s_nop 0
    buffer_load_dwordx4 v26, s[28:31], s41 offen lds
    s_mov_b32 m0, 27648
    s_nop 0
    buffer_load_dwordx4 v27, s[28:31], s41 offen lds
    s_mov_b32 m0, 28672
    s_nop 0
    buffer_load_dwordx4 v28, s[28:31], s41 offen lds
    s_mov_b32 m0, 29696
    s_nop 0
    buffer_load_dwordx4 v29, s[28:31], s41 offen lds
    s_mov_b32 m0, 30720
    s_nop 0
    buffer_load_dwordx4 v30, s[28:31], s41 offen lds
    s_mov_b32 m0, 31744
    s_nop 0
    buffer_load_dwordx4 v31, s[28:31], s41 offen lds
    s_mov_b32 s41, 131072
    s_mov_b32 m0, 32768
    s_nop 0
    buffer_load_dwordx4 v24, s[28:31], s41 offen lds
    s_mov_b32 m0, 33792
    s_nop 0
    buffer_load_dwordx4 v25, s[28:31], s41 offen lds
    s_mov_b32 m0, 34816
    s_nop 0
    buffer_load_dwordx4 v26, s[28:31], s41 offen lds
    s_mov_b32 m0, 35840
    s_nop 0
    buffer_load_dwordx4 v27, s[28:31], s41 offen lds
    s_mov_b32 m0, 36864
    s_nop 0
    buffer_load_dwordx4 v28, s[28:31], s41 offen lds
    s_mov_b32 m0, 37888
    s_nop 0
    buffer_load_dwordx4 v29, s[28:31], s41 offen lds
    s_mov_b32 m0, 38912
    s_nop 0
    buffer_load_dwordx4 v30, s[28:31], s41 offen lds
    s_mov_b32 m0, 39936
    s_nop 0
    buffer_load_dwordx4 v31, s[28:31], s41 offen lds
    s_mov_b32 s41, 163840
    s_mov_b32 m0, 40960
    s_nop 0
    buffer_load_dwordx4 v24, s[28:31], s41 offen lds
    s_mov_b32 m0, 41984
    s_nop 0
    buffer_load_dwordx4 v25, s[28:31], s41 offen lds
    s_mov_b32 m0, 43008
    s_nop 0
    buffer_load_dwordx4 v26, s[28:31], s41 offen lds
    s_mov_b32 m0, 44032
    s_nop 0
    buffer_load_dwordx4 v27, s[28:31], s41 offen lds
    s_mov_b32 m0, 45056
    s_nop 0
    buffer_load_dwordx4 v28, s[28:31], s41 offen lds
    s_mov_b32 m0, 46080
    s_nop 0
    buffer_load_dwordx4 v29, s[28:31], s41 offen lds
    s_mov_b32 m0, 47104
    s_nop 0
    buffer_load_dwordx4 v30, s[28:31], s41 offen lds
    s_mov_b32 m0, 48128
    s_nop 0
    buffer_load_dwordx4 v31, s[28:31], s41 offen lds
    s_mov_b32 s41, 196608
    s_mov_b32 m0, 49152
    s_nop 0
    buffer_load_dwordx4 v24, s[28:31], s41 offen lds
    s_mov_b32 m0, 50176
    s_nop 0
    buffer_load_dwordx4 v25, s[28:31], s41 offen lds
    s_mov_b32 m0, 51200
    s_nop 0
    buffer_load_dwordx4 v26, s[28:31], s41 offen lds
    s_mov_b32 m0, 52224
    s_nop 0
    buffer_load_dwordx4 v27, s[28:31], s41 offen lds
    s_mov_b32 m0, 53248
    s_nop 0
    buffer_load_dwordx4 v28, s[28:31], s41 offen lds
    s_mov_b32 m0, 54272
    s_nop 0
    buffer_load_dwordx4 v29, s[28:31], s41 offen lds
    s_mov_b32 m0, 55296
    s_nop 0
    buffer_load_dwordx4 v30, s[28:31], s41 offen lds
    s_mov_b32 m0, 56320
    s_nop 0
    buffer_load_dwordx4 v31, s[28:31], s41 offen lds
    s_waitcnt vmcnt(48)
    s_barrier
    s_mov_b32 s41, 229376
    s_mov_b32 m0, 57344
    s_nop 0
    buffer_load_dwordx4 v24, s[28:31], s41 offen lds
    s_mov_b32 m0, 58368
    s_nop 0
    buffer_load_dwordx4 v25, s[28:31], s41 offen lds
    s_mov_b32 m0, 59392
    s_nop 0
    buffer_load_dwordx4 v26, s[28:31], s41 offen lds
    s_mov_b32 m0, 60416
    s_nop 0
    buffer_load_dwordx4 v27, s[28:31], s41 offen lds
    s_mov_b32 m0, 61440
    s_nop 0
    buffer_load_dwordx4 v28, s[28:31], s41 offen lds
    s_mov_b32 m0, 62464
    s_nop 0
    buffer_load_dwordx4 v29, s[28:31], s41 offen lds
    s_mov_b32 m0, 63488
    s_nop 0
    buffer_load_dwordx4 v30, s[28:31], s41 offen lds
    s_mov_b32 m0, 64512
    s_nop 0
    buffer_load_dwordx4 v31, s[28:31], s41 offen lds
    s_waitcnt vmcnt(48)
    s_barrier
    s_mov_b32 s41, 262144
    s_mov_b32 m0, 0
    s_nop 0
    buffer_load_dwordx4 v24, s[28:31], s41 offen lds
    s_mov_b32 m0, 1024
    s_nop 0
    buffer_load_dwordx4 v25, s[28:31], s41 offen lds
    s_mov_b32 m0, 2048
    s_nop 0
    buffer_load_dwordx4 v26, s[28:31], s41 offen lds
    s_mov_b32 m0, 3072
    s_nop 0
    buffer_load_dwordx4 v27, s[28:31], s41 offen lds
    s_mov_b32 m0, 4096
    s_nop 0
    buffer_load_dwordx4 v28, s[28:31], s41 offen lds
    s_mov_b32 m0, 5120
    s_nop 0
    buffer_load_dwordx4 v29, s[28:31], s41 offen lds
    s_mov_b32 m0, 6144
    s_nop 0
    buffer_load_dwordx4 v30, s[28:31], s41 offen lds
    s_mov_b32 m0, 7168
    s_nop 0
    buffer_load_dwordx4 v31, s[28:31], s41 offen lds
    s_waitcnt vmcnt(48)
    s_barrier
    s_mov_b32 s41, 294912
    s_mov_b32 m0, 8192
    s_nop 0
    buffer_load_dwordx4 v24, s[28:31], s41 offen lds
    s_mov_b32 m0, 9216
    s_nop 0
    buffer_load_dwordx4 v25, s[28:31], s41 offen lds
    s_mov_b32 m0, 10240
    s_nop 0
    buffer_load_dwordx4 v26, s[28:31], s41 offen lds
    s_mov_b32 m0, 11264
    s_nop 0
    buffer_load_dwordx4 v27, s[28:31], s41 offen lds
    s_mov_b32 m0, 12288
    s_nop 0
    buffer_load_dwordx4 v28, s[28:31], s41 offen lds
    s_mov_b32 m0, 13312
    s_nop 0
    buffer_load_dwordx4 v29, s[28:31], s41 offen lds
    s_mov_b32 m0, 14336
    s_nop 0
    buffer_load_dwordx4 v30, s[28:31], s41 offen lds
    s_mov_b32 m0, 15360
    s_nop 0
    buffer_load_dwordx4 v31, s[28:31], s41 offen lds
    s_waitcnt vmcnt(48)
    s_barrier
    s_mov_b32 s41, 327680
    s_mov_b32 m0, 16384
    s_nop 0
    buffer_load_dwordx4 v24, s[28:31], s41 offen lds
    s_mov_b32 m0, 17408
    s_nop 0
    buffer_load_dwordx4 v25, s[28:31], s41 offen lds
    s_mov_b32 m0, 18432
    s_nop 0
    buffer_load_dwordx4 v26, s[28:31], s41 offen lds
    s_mov_b32 m0, 19456
    s_nop 0
    buffer_load_dwordx4 v27, s[28:31], s41 offen lds
    s_mov_b32 m0, 20480
    s_nop 0
    buffer_load_dwordx4 v28, s[28:31], s41 offen lds
    s_mov_b32 m0, 21504
    s_nop 0
    buffer_load_dwordx4 v29, s[28:31], s41 offen lds
    s_mov_b32 m0, 22528
    s_nop 0
    buffer_load_dwordx4 v30, s[28:31], s41 offen lds
    s_mov_b32 m0, 23552
    s_nop 0
    buffer_load_dwordx4 v31, s[28:31], s41 offen lds
    s_waitcnt vmcnt(48)
    s_barrier
    s_mov_b32 s41, 360448
    s_mov_b32 m0, 24576
    s_nop 0
    buffer_load_dwordx4 v24, s[28:31], s41 offen lds
    s_mov_b32 m0, 25600
    s_nop 0
    buffer_load_dwordx4 v25, s[28:31], s41 offen lds
    s_mov_b32 m0, 26624
    s_nop 0
    buffer_load_dwordx4 v26, s[28:31], s41 offen lds
    s_mov_b32 m0, 27648
    s_nop 0
    buffer_load_dwordx4 v27, s[28:31], s41 offen lds
    s_mov_b32 m0, 28672
    s_nop 0
    buffer_load_dwordx4 v28, s[28:31], s41 offen lds
    s_mov_b32 m0, 29696
    s_nop 0
    buffer_load_dwordx4 v29, s[28:31], s41 offen lds
    s_mov_b32 m0, 30720
    s_nop 0
    buffer_load_dwordx4 v30, s[28:31], s41 offen lds
    s_mov_b32 m0, 31744
    s_nop 0
    buffer_load_dwordx4 v31, s[28:31], s41 offen lds
    s_waitcnt vmcnt(48)
    s_barrier
    s_mov_b32 s41, 393216
    s_mov_b32 m0, 32768
    s_nop 0
    buffer_load_dwordx4 v24, s[28:31], s41 offen lds
    s_mov_b32 m0, 33792
    s_nop 0
    buffer_load_dwordx4 v25, s[28:31], s41 offen lds
    s_mov_b32 m0, 34816
    s_nop 0
    buffer_load_dwordx4 v26, s[28:31], s41 offen lds
    s_mov_b32 m0, 35840
    s_nop 0
    buffer_load_dwordx4 v27, s[28:31], s41 offen lds
    s_mov_b32 m0, 36864
    s_nop 0
    buffer_load_dwordx4 v28, s[28:31], s41 offen lds
    s_mov_b32 m0, 37888
    s_nop 0
    buffer_load_dwordx4 v29, s[28:31], s41 offen lds
    s_mov_b32 m0, 38912
    s_nop 0
    buffer_load_dwordx4 v30, s[28:31], s41 offen lds
    s_mov_b32 m0, 39936
    s_nop 0
    buffer_load_dwordx4 v31, s[28:31], s41 offen lds
    s_waitcnt vmcnt(48)
    s_barrier
    s_mov_b32 s41, 425984
    s_mov_b32 m0, 40960
    s_nop 0
    buffer_load_dwordx4 v24, s[28:31], s41 offen lds
    s_mov_b32 m0, 41984
    s_nop 0
    buffer_load_dwordx4 v25, s[28:31], s41 offen lds
    s_mov_b32 m0, 43008
    s_nop 0
    buffer_load_dwordx4 v26, s[28:31], s41 offen lds
    s_mov_b32 m0, 44032
    s_nop 0
    buffer_load_dwordx4 v27, s[28:31], s41 offen lds
    s_mov_b32 m0, 45056
    s_nop 0
    buffer_load_dwordx4 v28, s[28:31], s41 offen lds
    s_mov_b32 m0, 46080
    s_nop 0
    buffer_load_dwordx4 v29, s[28:31], s41 offen lds
    s_mov_b32 m0, 47104
    s_nop 0
    buffer_load_dwordx4 v30, s[28:31], s41 offen lds
    s_mov_b32 m0, 48128
    s_nop 0
    buffer_load_dwordx4 v31, s[28:31], s41 offen lds
    s_waitcnt vmcnt(48)
    s_barrier
    s_mov_b32 s41, 458752
    s_mov_b32 m0, 49152
    s_nop 0
    buffer_load_dwordx4 v24, s[28:31], s41 offen lds
    s_mov_b32 m0, 50176
    s_nop 0
    buffer_load_dwordx4 v25, s[28:31], s41 offen lds
    s_mov_b32 m0, 51200
    s_nop 0
    buffer_load_dwordx4 v26, s[28:31], s41 offen lds
    s_mov_b32 m0, 52224
    s_nop 0
    buffer_load_dwordx4 v27, s[28:31], s41 offen lds
    s_mov_b32 m0, 53248
    s_nop 0
    buffer_load_dwordx4 v28, s[28:31], s41 offen lds
    s_mov_b32 m0, 54272
    s_nop 0
    buffer_load_dwordx4 v29, s[28:31], s41 offen lds
    s_mov_b32 m0, 55296
    s_nop 0
    buffer_load_dwordx4 v30, s[28:31], s41 offen lds
    s_mov_b32 m0, 56320
    s_nop 0
    buffer_load_dwordx4 v31, s[28:31], s41 offen lds
    s_waitcnt vmcnt(48)
    s_barrier
    s_mov_b32 s41, 491520
    s_mov_b32 m0, 57344
    s_nop 0
    buffer_load_dwordx4 v24, s[28:31], s41 offen lds
    s_mov_b32 m0, 58368
    s_nop 0
    buffer_load_dwordx4 v25, s[28:31], s41 offen lds
    s_mov_b32 m0, 59392
    s_nop 0
    buffer_load_dwordx4 v26, s[28:31], s41 offen lds
    s_mov_b32 m0, 60416
    s_nop 0
    buffer_load_dwordx4 v27, s[28:31], s41 offen lds
    s_mov_b32 m0, 61440
    s_nop 0
    buffer_load_dwordx4 v28, s[28:31], s41 offen lds
    s_mov_b32 m0, 62464
    s_nop 0
    buffer_load_dwordx4 v29, s[28:31], s41 offen lds
    s_mov_b32 m0, 63488
    s_nop 0
    buffer_load_dwordx4 v30, s[28:31], s41 offen lds
    s_mov_b32 m0, 64512
    s_nop 0
    buffer_load_dwordx4 v31, s[28:31], s41 offen lds
    s_waitcnt vmcnt(48)
    s_barrier
    s_mov_b32 s41, 524288
    s_mov_b32 m0, 0
    s_nop 0
    buffer_load_dwordx4 v24, s[28:31], s41 offen lds
    s_mov_b32 m0, 1024
    s_nop 0
    buffer_load_dwordx4 v25, s[28:31], s41 offen lds
    s_mov_b32 m0, 2048
    s_nop 0
    buffer_load_dwordx4 v26, s[28:31], s41 offen lds
    s_mov_b32 m0, 3072
    s_nop 0
    buffer_load_dwordx4 v27, s[28:31], s41 offen lds
    s_mov_b32 m0, 4096
    s_nop 0
    buffer_load_dwordx4 v28, s[28:31], s41 offen lds
    s_mov_b32 m0, 5120
    s_nop 0
    buffer_load_dwordx4 v29, s[28:31], s41 offen lds
    s_mov_b32 m0, 6144
    s_nop 0
    buffer_load_dwordx4 v30, s[28:31], s41 offen lds
    s_mov_b32 m0, 7168
    s_nop 0
    buffer_load_dwordx4 v31, s[28:31], s41 offen lds
    s_waitcnt vmcnt(48)
    s_barrier
    s_mov_b32 s41, 557056
    s_mov_b32 m0, 8192
    s_nop 0
    buffer_load_dwordx4 v24, s[28:31], s41 offen lds
    s_mov_b32 m0, 9216
    s_nop 0
    buffer_load_dwordx4 v25, s[28:31], s41 offen lds
    s_mov_b32 m0, 10240
    s_nop 0
    buffer_load_dwordx4 v26, s[28:31], s41 offen lds
    s_mov_b32 m0, 11264
    s_nop 0
    buffer_load_dwordx4 v27, s[28:31], s41 offen lds
    s_mov_b32 m0, 12288
    s_nop 0
    buffer_load_dwordx4 v28, s[28:31], s41 offen lds
    s_mov_b32 m0, 13312
    s_nop 0
    buffer_load_dwordx4 v29, s[28:31], s41 offen lds
    s_mov_b32 m0, 14336
    s_nop 0
    buffer_load_dwordx4 v30, s[28:31], s41 offen lds
    s_mov_b32 m0, 15360
    s_nop 0
    buffer_load_dwordx4 v31, s[28:31], s41 offen lds
    s_waitcnt vmcnt(48)
    s_barrier
    s_mov_b32 s41, 589824
    s_mov_b32 m0, 16384
    s_nop 0
    buffer_load_dwordx4 v24, s[28:31], s41 offen lds
    s_mov_b32 m0, 17408
    s_nop 0
    buffer_load_dwordx4 v25, s[28:31], s41 offen lds
    s_mov_b32 m0, 18432
    s_nop 0
    buffer_load_dwordx4 v26, s[28:31], s41 offen lds
    s_mov_b32 m0, 19456
    s_nop 0
    buffer_load_dwordx4 v27, s[28:31], s41 offen lds
    s_mov_b32 m0, 20480
    s_nop 0
    buffer_load_dwordx4 v28, s[28:31], s41 offen lds
    s_mov_b32 m0, 21504
    s_nop 0
    buffer_load_dwordx4 v29, s[28:31], s41 offen lds
    s_mov_b32 m0, 22528
    s_nop 0
    buffer_load_dwordx4 v30, s[28:31], s41 offen lds
    s_mov_b32 m0, 23552
    s_nop 0
    buffer_load_dwordx4 v31, s[28:31], s41 offen lds
    s_waitcnt vmcnt(48)
    s_barrier
    s_mov_b32 s41, 622592
    s_mov_b32 m0, 24576
    s_nop 0
    buffer_load_dwordx4 v24, s[28:31], s41 offen lds
    s_mov_b32 m0, 25600
    s_nop 0
    buffer_load_dwordx4 v25, s[28:31], s41 offen lds
    s_mov_b32 m0, 26624
    s_nop 0
    buffer_load_dwordx4 v26, s[28:31], s41 offen lds
    s_mov_b32 m0, 27648
    s_nop 0
    buffer_load_dwordx4 v27, s[28:31], s41 offen lds
    s_mov_b32 m0, 28672
    s_nop 0
    buffer_load_dwordx4 v28, s[28:31], s41 offen lds
    s_mov_b32 m0, 29696
    s_nop 0
    buffer_load_dwordx4 v29, s[28:31], s41 offen lds
    s_mov_b32 m0, 30720
    s_nop 0
    buffer_load_dwordx4 v30, s[28:31], s41 offen lds
    s_mov_b32 m0, 31744
    s_nop 0
    buffer_load_dwordx4 v31, s[28:31], s41 offen lds
    s_waitcnt vmcnt(48)
    s_barrier
    s_mov_b32 s41, 655360
    s_mov_b32 m0, 32768
    s_nop 0
    buffer_load_dwordx4 v24, s[28:31], s41 offen lds
    s_mov_b32 m0, 33792
    s_nop 0
    buffer_load_dwordx4 v25, s[28:31], s41 offen lds
    s_mov_b32 m0, 34816
    s_nop 0
    buffer_load_dwordx4 v26, s[28:31], s41 offen lds
    s_mov_b32 m0, 35840
    s_nop 0
    buffer_load_dwordx4 v27, s[28:31], s41 offen lds
    s_mov_b32 m0, 36864
    s_nop 0
    buffer_load_dwordx4 v28, s[28:31], s41 offen lds
    s_mov_b32 m0, 37888
    s_nop 0
    buffer_load_dwordx4 v29, s[28:31], s41 offen lds
    s_mov_b32 m0, 38912
    s_nop 0
    buffer_load_dwordx4 v30, s[28:31], s41 offen lds
    s_mov_b32 m0, 39936
    s_nop 0
    buffer_load_dwordx4 v31, s[28:31], s41 offen lds
    s_waitcnt vmcnt(48)
    s_barrier
    s_mov_b32 s41, 688128
    s_mov_b32 m0, 40960
    s_nop 0
    buffer_load_dwordx4 v24, s[28:31], s41 offen lds
    s_mov_b32 m0, 41984
    s_nop 0
    buffer_load_dwordx4 v25, s[28:31], s41 offen lds
    s_mov_b32 m0, 43008
    s_nop 0
    buffer_load_dwordx4 v26, s[28:31], s41 offen lds
    s_mov_b32 m0, 44032
    s_nop 0
    buffer_load_dwordx4 v27, s[28:31], s41 offen lds
    s_mov_b32 m0, 45056
    s_nop 0
    buffer_load_dwordx4 v28, s[28:31], s41 offen lds
    s_mov_b32 m0, 46080
    s_nop 0
    buffer_load_dwordx4 v29, s[28:31], s41 offen lds
    s_mov_b32 m0, 47104
    s_nop 0
    buffer_load_dwordx4 v30, s[28:31], s41 offen lds
    s_mov_b32 m0, 48128
    s_nop 0
    buffer_load_dwordx4 v31, s[28:31], s41 offen lds
    s_waitcnt vmcnt(48)
    s_barrier
    s_mov_b32 s41, 720896
    s_mov_b32 m0, 49152
    s_nop 0
    buffer_load_dwordx4 v24, s[28:31], s41 offen lds
    s_mov_b32 m0, 50176
    s_nop 0
    buffer_load_dwordx4 v25, s[28:31], s41 offen lds
    s_mov_b32 m0, 51200
    s_nop 0
    buffer_load_dwordx4 v26, s[28:31], s41 offen lds
    s_mov_b32 m0, 52224
    s_nop 0
    buffer_load_dwordx4 v27, s[28:31], s41 offen lds
    s_mov_b32 m0, 53248
    s_nop 0
    buffer_load_dwordx4 v28, s[28:31], s41 offen lds
    s_mov_b32 m0, 54272
    s_nop 0
    buffer_load_dwordx4 v29, s[28:31], s41 offen lds
    s_mov_b32 m0, 55296
    s_nop 0
    buffer_load_dwordx4 v30, s[28:31], s41 offen lds
    s_mov_b32 m0, 56320
    s_nop 0
    buffer_load_dwordx4 v31, s[28:31], s41 offen lds
    s_waitcnt vmcnt(48)
    s_barrier
    s_mov_b32 s41, 753664
    s_mov_b32 m0, 57344
    s_nop 0
    buffer_load_dwordx4 v24, s[28:31], s41 offen lds
    s_mov_b32 m0, 58368
    s_nop 0
    buffer_load_dwordx4 v25, s[28:31], s41 offen lds
    s_mov_b32 m0, 59392
    s_nop 0
    buffer_load_dwordx4 v26, s[28:31], s41 offen lds
    s_mov_b32 m0, 60416
    s_nop 0
    buffer_load_dwordx4 v27, s[28:31], s41 offen lds
    s_mov_b32 m0, 61440
    s_nop 0
    buffer_load_dwordx4 v28, s[28:31], s41 offen lds
    s_mov_b32 m0, 62464
    s_nop 0
    buffer_load_dwordx4 v29, s[28:31], s41 offen lds
    s_mov_b32 m0, 63488
    s_nop 0
    buffer_load_dwordx4 v30, s[28:31], s41 offen lds
    s_mov_b32 m0, 64512
    s_nop 0
    buffer_load_dwordx4 v31, s[28:31], s41 offen lds
    s_waitcnt vmcnt(48)
    s_barrier
    s_mov_b32 s41, 786432
    s_mov_b32 m0, 0
    s_nop 0
    buffer_load_dwordx4 v24, s[28:31], s41 offen lds
    s_mov_b32 m0, 1024
    s_nop 0
    buffer_load_dwordx4 v25, s[28:31], s41 offen lds
    s_mov_b32 m0, 2048
    s_nop 0
    buffer_load_dwordx4 v26, s[28:31], s41 offen lds
    s_mov_b32 m0, 3072
    s_nop 0
    buffer_load_dwordx4 v27, s[28:31], s41 offen lds
    s_mov_b32 m0, 4096
    s_nop 0
    buffer_load_dwordx4 v28, s[28:31], s41 offen lds
    s_mov_b32 m0, 5120
    s_nop 0
    buffer_load_dwordx4 v29, s[28:31], s41 offen lds
    s_mov_b32 m0, 6144
    s_nop 0
    buffer_load_dwordx4 v30, s[28:31], s41 offen lds
    s_mov_b32 m0, 7168
    s_nop 0
    buffer_load_dwordx4 v31, s[28:31], s41 offen lds
    s_waitcnt vmcnt(48)
    s_barrier
    s_mov_b32 s41, 819200
    s_mov_b32 m0, 8192
    s_nop 0
    buffer_load_dwordx4 v24, s[28:31], s41 offen lds
    s_mov_b32 m0, 9216
    s_nop 0
    buffer_load_dwordx4 v25, s[28:31], s41 offen lds
    s_mov_b32 m0, 10240
    s_nop 0
    buffer_load_dwordx4 v26, s[28:31], s41 offen lds
    s_mov_b32 m0, 11264
    s_nop 0
    buffer_load_dwordx4 v27, s[28:31], s41 offen lds
    s_mov_b32 m0, 12288
    s_nop 0
    buffer_load_dwordx4 v28, s[28:31], s41 offen lds
    s_mov_b32 m0, 13312
    s_nop 0
    buffer_load_dwordx4 v29, s[28:31], s41 offen lds
    s_mov_b32 m0, 14336
    s_nop 0
    buffer_load_dwordx4 v30, s[28:31], s41 offen lds
    s_mov_b32 m0, 15360
    s_nop 0
    buffer_load_dwordx4 v31, s[28:31], s41 offen lds
    s_waitcnt vmcnt(48)
    s_barrier
    s_mov_b32 s41, 851968
    s_mov_b32 m0, 16384
    s_nop 0
    buffer_load_dwordx4 v24, s[28:31], s41 offen lds
    s_mov_b32 m0, 17408
    s_nop 0
    buffer_load_dwordx4 v25, s[28:31], s41 offen lds
    s_mov_b32 m0, 18432
    s_nop 0
    buffer_load_dwordx4 v26, s[28:31], s41 offen lds
    s_mov_b32 m0, 19456
    s_nop 0
    buffer_load_dwordx4 v27, s[28:31], s41 offen lds
    s_mov_b32 m0, 20480
    s_nop 0
    buffer_load_dwordx4 v28, s[28:31], s41 offen lds
    s_mov_b32 m0, 21504
    s_nop 0
    buffer_load_dwordx4 v29, s[28:31], s41 offen lds
    s_mov_b32 m0, 22528
    s_nop 0
    buffer_load_dwordx4 v30, s[28:31], s41 offen lds
    s_mov_b32 m0, 23552
    s_nop 0
    buffer_load_dwordx4 v31, s[28:31], s41 offen lds
    s_waitcnt vmcnt(48)
    s_barrier
    s_mov_b32 s41, 884736
    s_mov_b32 m0, 24576
    s_nop 0
    buffer_load_dwordx4 v24, s[28:31], s41 offen lds
    s_mov_b32 m0, 25600
    s_nop 0
    buffer_load_dwordx4 v25, s[28:31], s41 offen lds
    s_mov_b32 m0, 26624
    s_nop 0
    buffer_load_dwordx4 v26, s[28:31], s41 offen lds
    s_mov_b32 m0, 27648
    s_nop 0
    buffer_load_dwordx4 v27, s[28:31], s41 offen lds
    s_mov_b32 m0, 28672
    s_nop 0
    buffer_load_dwordx4 v28, s[28:31], s41 offen lds
    s_mov_b32 m0, 29696
    s_nop 0
    buffer_load_dwordx4 v29, s[28:31], s41 offen lds
    s_mov_b32 m0, 30720
    s_nop 0
    buffer_load_dwordx4 v30, s[28:31], s41 offen lds
    s_mov_b32 m0, 31744
    s_nop 0
    buffer_load_dwordx4 v31, s[28:31], s41 offen lds
    s_waitcnt vmcnt(48)
    s_barrier
    s_mov_b32 s41, 917504
    s_mov_b32 m0, 32768
    s_nop 0
    buffer_load_dwordx4 v24, s[28:31], s41 offen lds
    s_mov_b32 m0, 33792
    s_nop 0
    buffer_load_dwordx4 v25, s[28:31], s41 offen lds
    s_mov_b32 m0, 34816
    s_nop 0
    buffer_load_dwordx4 v26, s[28:31], s41 offen lds
    s_mov_b32 m0, 35840
    s_nop 0
    buffer_load_dwordx4 v27, s[28:31], s41 offen lds
    s_mov_b32 m0, 36864
    s_nop 0
    buffer_load_dwordx4 v28, s[28:31], s41 offen lds
    s_mov_b32 m0, 37888
    s_nop 0
    buffer_load_dwordx4 v29, s[28:31], s41 offen lds
    s_mov_b32 m0, 38912
    s_nop 0
    buffer_load_dwordx4 v30, s[28:31], s41 offen lds
    s_mov_b32 m0, 39936
    s_nop 0
    buffer_load_dwordx4 v31, s[28:31], s41 offen lds
    s_waitcnt vmcnt(48)
    s_barrier
    s_mov_b32 s41, 950272
    s_mov_b32 m0, 40960
    s_nop 0
    buffer_load_dwordx4 v24, s[28:31], s41 offen lds
    s_mov_b32 m0, 41984
    s_nop 0
    buffer_load_dwordx4 v25, s[28:31], s41 offen lds
    s_mov_b32 m0, 43008
    s_nop 0
    buffer_load_dwordx4 v26, s[28:31], s41 offen lds
    s_mov_b32 m0, 44032
    s_nop 0
    buffer_load_dwordx4 v27, s[28:31], s41 offen lds
    s_mov_b32 m0, 45056
    s_nop 0
    buffer_load_dwordx4 v28, s[28:31], s41 offen lds
    s_mov_b32 m0, 46080
    s_nop 0
    buffer_load_dwordx4 v29, s[28:31], s41 offen lds
    s_mov_b32 m0, 47104
    s_nop 0
    buffer_load_dwordx4 v30, s[28:31], s41 offen lds
    s_mov_b32 m0, 48128
    s_nop 0
    buffer_load_dwordx4 v31, s[28:31], s41 offen lds
    s_waitcnt vmcnt(48)
    s_barrier
    s_mov_b32 s41, 983040
    s_mov_b32 m0, 49152
    s_nop 0
    buffer_load_dwordx4 v24, s[28:31], s41 offen lds
    s_mov_b32 m0, 50176
    s_nop 0
    buffer_load_dwordx4 v25, s[28:31], s41 offen lds
    s_mov_b32 m0, 51200
    s_nop 0
    buffer_load_dwordx4 v26, s[28:31], s41 offen lds
    s_mov_b32 m0, 52224
    s_nop 0
    buffer_load_dwordx4 v27, s[28:31], s41 offen lds
    s_mov_b32 m0, 53248
    s_nop 0
    buffer_load_dwordx4 v28, s[28:31], s41 offen lds
    s_mov_b32 m0, 54272
    s_nop 0
    buffer_load_dwordx4 v29, s[28:31], s41 offen lds
    s_mov_b32 m0, 55296
    s_nop 0
    buffer_load_dwordx4 v30, s[28:31], s41 offen lds
    s_mov_b32 m0, 56320
    s_nop 0
    buffer_load_dwordx4 v31, s[28:31], s41 offen lds
    s_waitcnt vmcnt(48)
    s_barrier
    s_mov_b32 s41, 1015808
    s_mov_b32 m0, 57344
    s_nop 0
    buffer_load_dwordx4 v24, s[28:31], s41 offen lds
    s_mov_b32 m0, 58368
    s_nop 0
    buffer_load_dwordx4 v25, s[28:31], s41 offen lds
    s_mov_b32 m0, 59392
    s_nop 0
    buffer_load_dwordx4 v26, s[28:31], s41 offen lds
    s_mov_b32 m0, 60416
    s_nop 0
    buffer_load_dwordx4 v27, s[28:31], s41 offen lds
    s_mov_b32 m0, 61440
    s_nop 0
    buffer_load_dwordx4 v28, s[28:31], s41 offen lds
    s_mov_b32 m0, 62464
    s_nop 0
    buffer_load_dwordx4 v29, s[28:31], s41 offen lds
    s_mov_b32 m0, 63488
    s_nop 0
    buffer_load_dwordx4 v30, s[28:31], s41 offen lds
    s_mov_b32 m0, 64512
    s_nop 0
    buffer_load_dwordx4 v31, s[28:31], s41 offen lds
    s_waitcnt vmcnt(48)
    s_barrier
    s_waitcnt vmcnt(40)
    s_barrier
    s_waitcnt vmcnt(32)
    s_barrier
    s_waitcnt vmcnt(24)
    s_barrier
    s_waitcnt vmcnt(16)
    s_barrier
    s_waitcnt vmcnt(8)
    s_barrier
    s_waitcnt vmcnt(0)
    s_barrier
    s_branch B_end
B_end:
    s_endpgm
.globl reduce_kernel
.p2align 8
.type reduce_kernel,@function
reduce_kernel:
    s_cmp_ge_u32 s2, 384
    s_cbranch_scc1 C_end
    s_load_dwordx2 s[8:9], s[0:1], 80
    s_load_dwordx2 s[16:17], s[0:1], 96
    s_waitcnt lgkmcnt(0)
    s_add_u32 s36, s16, 16777216
    s_addc_u32 s37, s17, 0
    s_and_b32 s37, s37, 0xffff
    s_mov_b32 s38, 25165824
    s_mov_b32 s39, 0x20000
    s_mov_b32 s32, s8
    s_and_b32 s33, s9, 0xffff
    s_mov_b32 s34, 1572864
    s_mov_b32 s35, 0x20000
    s_lshl_b32 s3, s2, 8
    v_add_u32 v1, s3, v0
    v_lshlrev_b32 v2, 5, v1
    s_mov_b32 s41, 0
    buffer_load_dwordx4 v[8:11], v2, s[36:39], s41 offen
    buffer_load_dwordx4 v[12:15], v2, s[36:39], s41 offen offset:16
    s_mov_b32 s41, 3145728
    buffer_load_dwordx4 v[16:19], v2, s[36:39], s41 offen
    buffer_load_dwordx4 v[20:23], v2, s[36:39], s41 offen offset:16
    s_mov_b32 s41, 6291456
    buffer_load_dwordx4 v[24:27], v2, s[36:39], s41 offen
    buffer_load_dwordx4 v[28:31], v2, s[36:39], s41 offen offset:16
    s_mov_b32 s41, 9437184
    buffer_load_dwordx4 v[32:35], v2, s[36:39], s41 offen
    buffer_load_dwordx4 v[36:39], v2, s[36:39], s41 offen offset:16
    v_lshrrev_b32 v3, 6, v1
    v_and_b32 v4, 63, v1
    v_cmp_le_u32 vcc, 768, v3
    s_nop 1
    v_cndmask_b32 v5, 0, 1, vcc
    v_mul_u32_u24 v6, 768, v5
    v_sub_u32 v3, v3, v6
    v_lshlrev_b32 v3, 11, v3
    v_lshl_add_u32 v3, v5, 10, v3
    v_lshl_add_u32 v3, v4, 4, v3
    s_waitcnt vmcnt(0)
    v_add_f32 v8, v8, v16
    v_add_f32 v9, v9, v17
    v_add_f32 v10, v10, v18
    v_add_f32 v11, v11, v19
    v_add_f32 v12, v12, v20
    v_add_f32 v13, v13, v21
    v_add_f32 v14, v14, v22
    v_add_f32 v15, v15, v23
    v_add_f32 v8, v8, v24
    v_add_f32 v9, v9, v25
    v_add_f32 v10, v10, v26
    v_add_f32 v11, v11, v27
    v_add_f32 v12, v12, v28
    v_add_f32 v13, v13, v29
    v_add_f32 v14, v14, v30
    v_add_f32 v15, v15, v31
    v_add_f32 v8, v8, v32
    v_add_f32 v9, v9, v33
    v_add_f32 v10, v10, v34
    v_add_f32 v11, v11, v35
    v_add_f32 v12, v12, v36
    v_add_f32 v13, v13, v37
    v_add_f32 v14, v14, v38
    v_add_f32 v15, v15, v39
    v_cvt_pk_bf16_f32 v80, v8, v9
    v_cvt_pk_bf16_f32 v81, v10, v11
    v_cvt_pk_bf16_f32 v82, v12, v13
    v_cvt_pk_bf16_f32 v83, v14, v15
    buffer_store_dwordx4 v[80:83], v3, s[32:35], 0 offen
C_end:
    s_endpgm
.section .rodata,"a"
.p2align 6
.amdhsa_kernel attn_kernel
  .amdhsa_next_free_vgpr 208
  .amdhsa_next_free_sgpr 96
  .amdhsa_accum_offset 208
  .amdhsa_group_segment_fixed_size 0
  .amdhsa_kernarg_size 104
  .amdhsa_user_sgpr_count 2
  .amdhsa_user_sgpr_kernarg_segment_ptr 1
  .amdhsa_system_sgpr_workgroup_id_x 1
.end_amdhsa_kernel
.p2align 6
.amdhsa_kernel oproj_kernel
  .amdhsa_next_free_vgpr 208
  .amdhsa_next_free_sgpr 96
  .amdhsa_accum_offset 208
  .amdhsa_group_segment_fixed_size 0
  .amdhsa_kernarg_size 104
  .amdhsa_user_sgpr_count 2
  .amdhsa_user_sgpr_kernarg_segment_ptr 1
  .amdhsa_system_sgpr_workgroup_id_x 1
.end_amdhsa_kernel
.p2align 6
.amdhsa_kernel reduce_kernel
  .amdhsa_next_free_vgpr 88
  .amdhsa_next_free_sgpr 96
  .amdhsa_accum_offset 88
  .amdhsa_group_segment_fixed_size 0
  .amdhsa_kernarg_size 104
  .amdhsa_user_sgpr_count 2
  .amdhsa_user_sgpr_kernarg_segment_ptr 1
  .amdhsa_system_sgpr_workgroup_id_x 1
.end_amdhsa_kernel
```
